```python
import torch

def _softmax(x, axis=-1):
    return torch.softmax(x, dim=axis)
def _gelu(x):
    return torch.nn.functional.gelu(x, approximate="tanh")
def _silu(x):
    return torch.nn.functional.silu(x)
def _sigmoid(x):
    return torch.sigmoid(x)
def _layernorm(x, axis=-1, eps=1e-5):
    m = x.mean(dim=axis, keepdim=True)
    v = x.var(dim=axis, keepdim=True, unbiased=False)
    return (x - m) / torch.sqrt(v + eps)
def _scatter_add(tgt, idx, src, axis=0):
    return tgt.clone().index_add_(axis, idx, src)
def _segment_sum(src, seg, n):
    out = torch.zeros((n,) + src.shape[1:], dtype=src.dtype)
    return out.index_add_(0, seg, src)
def _pad(x, pw):
    flat = tuple(v for pair in reversed(pw) for v in pair)
    return torch.nn.functional.pad(x, flat)

kernel_name = 'standalone__kv_cache_quant_int4_int2_kv_with_per_channel_or_per_token_scales__sampling'

def setup_inputs():

    _w = (lambda a: (lambda t: t.to(torch.bfloat16) if t.is_floating_point() else t)(torch.as_tensor(a)))
    B = 16
    Sq = 1
    Skv = 4096
    Hq = 32
    Hkv = 8
    Dh = 128
    bits = 8
    G = 128
    if G <= 0 or G >= Skv:
        G = max(1, Skv // 2)
    Skv = (Skv // G) * G
    ngk = Skv // G
    qmax = (1 << bits) - 1
    return {
        "q": _w((lambda *s: torch.randn(*s, dtype=torch.bfloat16) * 0.4)(B, Hq, Sq, Dh)),
        "qk": _w(torch.randint(0, qmax + 1, (B, Hkv, Skv, Dh)).to(torch.int32)),
        "qv": _w(torch.randint(0, qmax + 1, (B, Hkv, Skv, Dh)).to(torch.int32)),
        "k_scales": _w(torch.abs((lambda *s: torch.randn(*s, dtype=torch.bfloat16) * 0.4)(B, Hkv, ngk, Dh)) * 0.05 + 0.02),
        "k_zeros": _w((lambda *s: torch.randn(*s, dtype=torch.bfloat16) * 0.4)(B, Hkv, ngk, Dh) + float(qmax) / 2.0),
        "v_scales": _w(torch.abs((lambda *s: torch.randn(*s, dtype=torch.bfloat16) * 0.05)(B, Hkv, Skv, 1)) * 0.05 + 0.02),
        "v_zeros": _w((lambda *s: torch.randn(*s, dtype=torch.bfloat16) * 0.05)(B, Hkv, Skv, 1) + float(qmax) / 2.0),
    }

def reference(q, qk, qv, k_scales, k_zeros, v_scales, v_zeros):
    B, Hq, Sq, Dh = q.shape
    Hkv, Skv = qk.shape[1], qk.shape[2]
    ngk = k_scales.shape[2]
    G = Skv // ngk
    ks = (lambda x, n, axis: torch.repeat_interleave(x, n, dim=axis))(k_scales, G, axis=2)
    kz = (lambda x, n, axis: torch.repeat_interleave(x, n, dim=axis))(k_zeros, G, axis=2)
    k = ((lambda x, dt: x.to(dt))(qk, q.dtype) - kz) * ks
    v = ((lambda x, dt: x.to(dt))(qv, q.dtype) - v_zeros) * v_scales
    rep = Hq // Hkv
    if rep > 1:
        k = (lambda x, n, axis: torch.repeat_interleave(x, n, dim=axis))(k, rep, axis=1)
        v = (lambda x, n, axis: torch.repeat_interleave(x, n, dim=axis))(v, rep, axis=1)
    scale = float(Dh) ** -0.5
    logits = torch.einsum("bhqd,bhkd->bhqk", q, k) * scale
    p = _softmax(logits, axis=-1)
    o = torch.einsum("bhqk,bhkd->bhqd", p, v)
    return o
```

```asm
; @launch grid=(256,1,1) block=(256,1,1) lds=90112
.amdgcn_target "amdgcn-amd-amdhsa--gfx950"
.text
.globl standalone__kv_cache_quant_int4_int2_kv_with_per_channel_or_per_token_scales__sampling_kernel
.p2align 8
.type standalone__kv_cache_quant_int4_int2_kv_with_per_channel_or_per_token_scales__sampling_kernel,@function
standalone__kv_cache_quant_int4_int2_kv_with_per_channel_or_per_token_scales__sampling_kernel:
  s_cmp_ge_u32 s2, 256
  s_cbranch_scc1 L_end
  s_load_dwordx16 s[4:19], s[0:1], 0
  s_load_dwordx4 s[20:23], s[0:1], 64
  v_lshrrev_b32 v1, 6, v0
  v_and_b32 v0, 63, v0
  s_and_b32 s33, s2, 3
  s_lshl_b32 s33, s33, 1
  s_bfe_u32 s34, s2, 0x10002
  s_or_b32 s33, s33, s34
  s_andn2_b32 s2, s2, 7
  s_or_b32 s2, s2, s33
  s_lshr_b32 s33, s2, 1
  v_readfirstlane_b32 s3, v1
  v_and_b32 v20, 15, v0
  v_lshrrev_b32 v21, 4, v0
  v_lshlrev_b32 v1, 9, v20
  v_lshl_add_u32 v1, v21, 4, v1
  v_and_b32 v22, 14, v0
  v_lshlrev_b32 v9, 9, v22
  v_lshl_add_u32 v9, v21, 5, v9
  v_and_b32 v22, 1, v0
  v_lshl_add_u32 v9, v22, 4, v9
  v_lshlrev_b32 v2, 3, v20
  v_lshl_add_u32 v2, v21, 11, v2
  s_lshl_b32 s36, s2, 20
  s_lshl_b32 s37, s3, 13
  s_add_u32 s36, s36, s37
  s_mov_b32 s32, s36
  v_lshrrev_b32 v22, 2, v20
  v_and_b32 v23, 3, v20
  v_and_b32 v24, 1, v21
  v_mad_i32_i24 v24, v24, 0, 2
  v_cmp_gt_u32 vcc, v24, v22
  v_lshlrev_b32 v24, 4, v23
  v_lshlrev_b32 v25, 3, v23
  v_cndmask_b32 v24, v24, v25, vcc
  v_lshl_add_u32 v24, v22, 6, v24
  v_cndmask_b32 v14, 8, 32, vcc
  v_add_u32 v14, v14, v24
  v_lshl_add_u32 v25, v21, 8, v24
  v_lshl_add_u32 v15, v21, 8, v14
  v_lshlrev_b32 v26, 4, v0
  s_lshl_b32 s38, s2, 12
  s_lshl_b32 s37, s3, 10
  s_add_u32 s38, s38, s37
  s_lshl_b32 s39, s33, 10
  s_waitcnt lgkmcnt(0)
  s_mov_b32 s24, s10
  s_and_b32 s25, s11, 0xffff
  s_mov_b32 s26, 1048576
  s_mov_b32 s27, 0x20000
  s_mov_b32 s28, s12
  s_and_b32 s29, s13, 0xffff
  s_mov_b32 s30, 1048576
  s_mov_b32 s31, 0x20000
  s_mov_b32 s48, s4
  s_and_b32 s49, s5, 0xffff
  s_mov_b32 s50, 131072
  s_mov_b32 s51, 0x20000
  buffer_load_dwordx2 v[28:29], v25, s[24:27], s38 offen nt
  buffer_load_dwordx2 v[30:31], v15, s[24:27], s38 offen nt
  buffer_load_dwordx2 v[32:33], v25, s[28:31], s38 offen nt
  buffer_load_dwordx2 v[34:35], v15, s[28:31], s38 offen nt
  buffer_load_dwordx2 v[44:45], v24, s[48:51], s39 offen offset:0 nt
  buffer_load_dwordx2 v[46:47], v14, s[48:51], s39 offen offset:0 nt
  buffer_load_dwordx2 v[48:49], v24, s[48:51], s39 offen offset:256 nt
  buffer_load_dwordx2 v[50:51], v14, s[48:51], s39 offen offset:256 nt
  buffer_load_dwordx2 v[52:53], v24, s[48:51], s39 offen offset:512 nt
  buffer_load_dwordx2 v[54:55], v14, s[48:51], s39 offen offset:512 nt
  buffer_load_dwordx2 v[56:57], v24, s[48:51], s39 offen offset:768 nt
  buffer_load_dwordx2 v[58:59], v14, s[48:51], s39 offen offset:768 nt
  s_mov_b32 s64, s14
  s_and_b32 s65, s15, 0xffff
  s_mov_b32 s66, 1048576
  s_mov_b32 s67, 0x20000
  s_mov_b32 s72, s16
  s_and_b32 s73, s17, 0xffff
  s_mov_b32 s74, 1048576
  s_mov_b32 s75, 0x20000
  s_lshl_b32 s37, s3, 10
  s_add_u32 m0, s37, 17408
  s_nop 0
  buffer_load_dwordx4 v26, s[64:67], s38 offen nt lds
  s_add_u32 m0, s37, 21504
  s_nop 0
  buffer_load_dwordx4 v26, s[72:75], s38 offen nt lds
  s_mov_b32 s40, s6
  s_and_b32 s41, s7, 0xffff
  s_mov_b32 s42, 268435456
  s_mov_b32 s43, 0x20000
  s_mov_b32 s44, s8
  s_and_b32 s45, s9, 0xffff
  s_mov_b32 s46, 268435456
  s_mov_b32 s47, 0x20000
  buffer_load_dwordx4 v[120:123], v9, s[40:43], s36 offen offset:384 nt
  buffer_load_dwordx4 v[124:127], v9, s[40:43], s36 offen offset:896 nt
  buffer_load_dwordx4 v[112:115], v9, s[40:43], s36 offen offset:256 nt
  buffer_load_dwordx4 v[116:119], v9, s[40:43], s36 offen offset:768 nt
  buffer_load_dwordx4 v[104:107], v1, s[40:43], s36 offen offset:128 nt
  buffer_load_dwordx4 v[108:111], v1, s[40:43], s36 offen offset:192 nt
  buffer_load_dwordx4 v[96:99], v1, s[40:43], s36 offen offset:0 nt
  buffer_load_dwordx4 v[100:103], v1, s[40:43], s36 offen offset:64 nt
  s_add_u32 s36, s36, 32768
  buffer_load_dwordx4 v[152:155], v9, s[40:43], s36 offen offset:384 nt
  buffer_load_dwordx4 v[156:159], v9, s[40:43], s36 offen offset:896 nt
  buffer_load_dwordx4 v[144:147], v9, s[40:43], s36 offen offset:256 nt
  buffer_load_dwordx4 v[148:151], v9, s[40:43], s36 offen offset:768 nt
  buffer_load_dwordx4 v[136:139], v1, s[40:43], s36 offen offset:128 nt
  buffer_load_dwordx4 v[140:143], v1, s[40:43], s36 offen offset:192 nt
  buffer_load_dwordx4 v[128:131], v1, s[40:43], s36 offen offset:0 nt
  buffer_load_dwordx4 v[132:135], v1, s[40:43], s36 offen offset:64 nt
  s_add_u32 s36, s36, 32768
  s_mov_b32 s52, s22
  s_and_b32 s53, s23, 0xffff
  s_mov_b32 s54, 2097152
  s_mov_b32 s55, 0x20000
  s_mov_b32 s56, s18
  s_and_b32 s57, s19, 0xffff
  s_mov_b32 s58, 131072
  s_mov_b32 s59, 0x20000
  s_lshl_b32 s87, s2, 12
  s_xor_b32 s88, s87, 4096
  s_and_b32 s89, s33, 1
  s_lshl_b32 s89, s89, 4
  s_lshl_b32 s90, 1, s89
  s_lshr_b32 s91, s33, 1
  s_lshl_b32 s91, s91, 2
  s_mov_b32 s92, 0x55555555
  s_mov_b32 s93, s92
  s_mov_b32 s94, 0xaaaaaaaa
  s_mov_b32 s95, s94
  s_mov_b32 s68, 0xf0f0f0f0
  s_mov_b32 s69, s68
  s_mov_b32 s60, 0xff00ff00
  s_mov_b32 s61, s60
  v_and_b32 v4, 3, v0
  v_lshlrev_b32 v3, 6, v4
  v_lshl_add_u32 v3, v21, 4, v3
  v_lshlrev_b32 v4, 2, v4
  v_add_u32 v4, 16384, v4
  s_lshl_b32 s37, s3, 5
  s_add_u32 s37, s37, 17408
  v_lshl_add_u32 v18, v21, 3, s37
  v_lshl_add_u32 v5, v22, 1, v18
  s_lshl_b32 s37, s3, 13
  s_add_u32 s37, s37, 34816
  v_lshl_add_u32 v19, v0, 2, s37
  s_lshl_b32 s37, s3, 2
  v_add_u32 v27, s37, v21
  v_lshlrev_b32 v24, 10, v27
  v_lshl_add_u32 v24, v22, 8, v24
  v_lshl_add_u32 v24, v23, 4, v24
  v_lshlrev_b32 v25, 4, v27
  v_add_u32 v25, 16384, v25
  s_mov_b32 s37, 0x3e0293ee
  s_mov_b32 s76, 0xffff0000
  s_waitcnt vmcnt(16)
  s_mov_b32 s78, s37
  v_lshlrev_b32 v60, 16, v28
  v_and_b32 v61, s76, v28
  v_lshlrev_b32 v62, 16, v29
  v_and_b32 v63, s76, v29
  v_lshlrev_b32 v64, 16, v30
  v_and_b32 v65, s76, v30
  v_lshlrev_b32 v66, 16, v31
  v_and_b32 v67, s76, v31
  v_pk_mul_f32 v[60:61], v[60:61], s[78:79] op_sel_hi:[1,0]
  v_pk_mul_f32 v[62:63], v[62:63], s[78:79] op_sel_hi:[1,0]
  v_pk_mul_f32 v[64:65], v[64:65], s[78:79] op_sel_hi:[1,0]
  v_pk_mul_f32 v[66:67], v[66:67], s[78:79] op_sel_hi:[1,0]
  v_lshlrev_b32 v76, 16, v44
  v_and_b32 v77, s76, v44
  v_lshlrev_b32 v78, 16, v45
  v_and_b32 v79, s76, v45
  v_lshlrev_b32 v80, 16, v46
  v_and_b32 v81, s76, v46
  v_lshlrev_b32 v82, 16, v47
  v_and_b32 v83, s76, v47
  v_pk_mul_f32 v[76:77], v[76:77], v[60:61]
  v_pk_mul_f32 v[78:79], v[78:79], v[62:63]
  v_pk_mul_f32 v[80:81], v[80:81], v[64:65]
  v_pk_mul_f32 v[82:83], v[82:83], v[66:67]
  v_cvt_pk_bf16_f32 v44, v76, v77
  v_cvt_pk_bf16_f32 v45, v78, v79
  v_cvt_pk_bf16_f32 v46, v80, v81
  v_cvt_pk_bf16_f32 v47, v82, v83
  ds_write_b128 v24, v[44:47] offset:0
  v_dot2_f32_bf16 v10, v44, v32, 0
  v_dot2_f32_bf16 v10, v45, v33, v10
  v_dot2_f32_bf16 v10, v46, v34, v10
  v_dot2_f32_bf16 v10, v47, v35, v10
  v_lshlrev_b32 v76, 16, v48
  v_and_b32 v77, s76, v48
  v_lshlrev_b32 v78, 16, v49
  v_and_b32 v79, s76, v49
  v_lshlrev_b32 v80, 16, v50
  v_and_b32 v81, s76, v50
  v_lshlrev_b32 v82, 16, v51
  v_and_b32 v83, s76, v51
  v_pk_mul_f32 v[76:77], v[76:77], v[60:61]
  v_pk_mul_f32 v[78:79], v[78:79], v[62:63]
  v_pk_mul_f32 v[80:81], v[80:81], v[64:65]
  v_pk_mul_f32 v[82:83], v[82:83], v[66:67]
  v_cvt_pk_bf16_f32 v48, v76, v77
  v_cvt_pk_bf16_f32 v49, v78, v79
  v_cvt_pk_bf16_f32 v50, v80, v81
  v_cvt_pk_bf16_f32 v51, v82, v83
  ds_write_b128 v24, v[48:51] offset:64
  v_dot2_f32_bf16 v11, v48, v32, 0
  v_dot2_f32_bf16 v11, v49, v33, v11
  v_dot2_f32_bf16 v11, v50, v34, v11
  v_dot2_f32_bf16 v11, v51, v35, v11
  v_lshlrev_b32 v76, 16, v52
  v_and_b32 v77, s76, v52
  v_lshlrev_b32 v78, 16, v53
  v_and_b32 v79, s76, v53
  v_lshlrev_b32 v80, 16, v54
  v_and_b32 v81, s76, v54
  v_lshlrev_b32 v82, 16, v55
  v_and_b32 v83, s76, v55
  v_pk_mul_f32 v[76:77], v[76:77], v[60:61]
  v_pk_mul_f32 v[78:79], v[78:79], v[62:63]
  v_pk_mul_f32 v[80:81], v[80:81], v[64:65]
  v_pk_mul_f32 v[82:83], v[82:83], v[66:67]
  v_cvt_pk_bf16_f32 v52, v76, v77
  v_cvt_pk_bf16_f32 v53, v78, v79
  v_cvt_pk_bf16_f32 v54, v80, v81
  v_cvt_pk_bf16_f32 v55, v82, v83
  ds_write_b128 v24, v[52:55] offset:128
  v_dot2_f32_bf16 v12, v52, v32, 0
  v_dot2_f32_bf16 v12, v53, v33, v12
  v_dot2_f32_bf16 v12, v54, v34, v12
  v_dot2_f32_bf16 v12, v55, v35, v12
  v_lshlrev_b32 v76, 16, v56
  v_and_b32 v77, s76, v56
  v_lshlrev_b32 v78, 16, v57
  v_and_b32 v79, s76, v57
  v_lshlrev_b32 v80, 16, v58
  v_and_b32 v81, s76, v58
  v_lshlrev_b32 v82, 16, v59
  v_and_b32 v83, s76, v59
  v_pk_mul_f32 v[76:77], v[76:77], v[60:61]
  v_pk_mul_f32 v[78:79], v[78:79], v[62:63]
  v_pk_mul_f32 v[80:81], v[80:81], v[64:65]
  v_pk_mul_f32 v[82:83], v[82:83], v[66:67]
  v_cvt_pk_bf16_f32 v56, v76, v77
  v_cvt_pk_bf16_f32 v57, v78, v79
  v_cvt_pk_bf16_f32 v58, v80, v81
  v_cvt_pk_bf16_f32 v59, v82, v83
  ds_write_b128 v24, v[56:59] offset:192
  v_dot2_f32_bf16 v13, v56, v32, 0
  v_dot2_f32_bf16 v13, v57, v33, v13
  v_dot2_f32_bf16 v13, v58, v34, v13
  v_dot2_f32_bf16 v13, v59, v35, v13
  s_nop 2
  v_add_f32_dpp v10, v10, v10 row_ror:8 row_mask:0xf bank_mask:0xf
  v_add_f32_dpp v11, v11, v11 row_ror:8 row_mask:0xf bank_mask:0xf
  v_add_f32_dpp v12, v12, v12 row_ror:8 row_mask:0xf bank_mask:0xf
  v_add_f32_dpp v13, v13, v13 row_ror:8 row_mask:0xf bank_mask:0xf
  s_nop 0
  v_add_f32_dpp v10, v10, v10 row_ror:4 row_mask:0xf bank_mask:0xf
  v_add_f32_dpp v11, v11, v11 row_ror:4 row_mask:0xf bank_mask:0xf
  v_add_f32_dpp v12, v12, v12 row_ror:4 row_mask:0xf bank_mask:0xf
  v_add_f32_dpp v13, v13, v13 row_ror:4 row_mask:0xf bank_mask:0xf
  s_nop 0
  v_add_f32_dpp v10, v10, v10 row_ror:2 row_mask:0xf bank_mask:0xf
  v_add_f32_dpp v11, v11, v11 row_ror:2 row_mask:0xf bank_mask:0xf
  v_add_f32_dpp v12, v12, v12 row_ror:2 row_mask:0xf bank_mask:0xf
  v_add_f32_dpp v13, v13, v13 row_ror:2 row_mask:0xf bank_mask:0xf
  s_nop 0
  v_add_f32_dpp v10, v10, v10 row_ror:1 row_mask:0xf bank_mask:0xf
  v_add_f32_dpp v11, v11, v11 row_ror:1 row_mask:0xf bank_mask:0xf
  v_add_f32_dpp v12, v12, v12 row_ror:1 row_mask:0xf bank_mask:0xf
  v_add_f32_dpp v13, v13, v13 row_ror:1 row_mask:0xf bank_mask:0xf
  ds_write_b128 v25, v[10:13]
  s_cmp_lg_u32 s3, 0
  s_cbranch_scc1 L_noclear
  v_mov_b32 v92, -1
  v_mov_b32 v93, -1
  v_mov_b32 v94, -1
  v_mov_b32 v95, -1
  v_lshlrev_b32 v27, 3, v0
  buffer_store_dwordx4 v[92:95], v26, s[52:55], s87 offen sc0 sc1
  buffer_store_dwordx4 v[92:95], v26, s[52:55], s87 offen offset:1024 sc0 sc1
  buffer_store_dwordx2 v[92:93], v27, s[52:55], s87 offen offset:2048 sc0 sc1
  s_nop 1
L_noclear:
  v_mov_b32 v60, 0
  v_mov_b32 v61, 0
  v_mov_b32 v62, 0
  v_mov_b32 v63, 0
  v_mov_b32 v64, 0
  v_mov_b32 v65, 0
  v_mov_b32 v66, 0
  v_mov_b32 v67, 0
  v_mov_b32 v68, 0
  v_mov_b32 v69, 0
  v_mov_b32 v70, 0
  v_mov_b32 v71, 0
  v_mov_b32 v72, 0
  v_mov_b32 v73, 0
  v_mov_b32 v74, 0
  v_mov_b32 v75, 0
  v_mov_b32 v76, 0
  v_mov_b32 v77, 0
  v_mov_b32 v78, 0
  v_mov_b32 v79, 0
  v_mov_b32 v80, 0
  v_mov_b32 v81, 0
  v_mov_b32 v82, 0
  v_mov_b32 v83, 0
  v_mov_b32 v84, 0
  v_mov_b32 v85, 0
  v_mov_b32 v86, 0
  v_mov_b32 v87, 0
  v_mov_b32 v88, 0
  v_mov_b32 v89, 0
  v_mov_b32 v90, 0
  v_mov_b32 v91, 0
  v_mov_b32 v92, 0
  v_mov_b32 v93, 0
  v_mov_b32 v94, 0
  v_mov_b32 v95, 0
  v_mov_b32 v6, 0xff7fffff
  v_mov_b32 v7, 0
  s_waitcnt lgkmcnt(0)
  s_barrier
  ds_read_b128 v[28:31], v3 offset:0
  ds_read_b128 v[32:35], v3 offset:256
  ds_read_b128 v[36:39], v3 offset:512
  ds_read_b128 v[40:43], v3 offset:768
  ds_read_b32 v8, v4
  v_add_u32 v3, 1024, v3
  v_add_u32 v4, 16, v4
  s_mov_b32 s77, 15
L_loopK:
  s_waitcnt vmcnt(14)
  v_cvt_f32_i32 v120, v120
  v_cvt_f32_i32 v121, v121
  v_cvt_f32_i32 v122, v122
  v_cvt_f32_i32 v123, v123
  v_cvt_f32_i32 v124, v124
  v_cvt_f32_i32 v125, v125
  v_cvt_f32_i32 v126, v126
  v_cvt_f32_i32 v127, v127
  v_cvt_pk_bf16_f32 v120, v120, v121
  v_cvt_pk_bf16_f32 v121, v122, v123
  v_cvt_pk_bf16_f32 v122, v124, v125
  v_cvt_pk_bf16_f32 v123, v126, v127
  s_waitcnt vmcnt(12)
  v_cvt_f32_i32 v112, v112
  v_cvt_f32_i32 v113, v113
  v_cvt_f32_i32 v114, v114
  v_cvt_f32_i32 v115, v115
  v_cvt_f32_i32 v116, v116
  v_cvt_f32_i32 v117, v117
  v_cvt_f32_i32 v118, v118
  v_cvt_f32_i32 v119, v119
  v_cvt_pk_bf16_f32 v112, v112, v113
  v_cvt_pk_bf16_f32 v113, v114, v115
  v_cvt_pk_bf16_f32 v114, v116, v117
  v_cvt_pk_bf16_f32 v115, v118, v119
  s_waitcnt vmcnt(10)
  v_cvt_f32_i32 v104, v104
  v_cvt_f32_i32 v105, v105
  v_cvt_f32_i32 v106, v106
  v_cvt_f32_i32 v107, v107
  v_cvt_f32_i32 v108, v108
  v_cvt_f32_i32 v109, v109
  v_cvt_f32_i32 v110, v110
  v_cvt_f32_i32 v111, v111
  v_cvt_pk_bf16_f32 v48, v104, v105
  v_cvt_pk_bf16_f32 v49, v106, v107
  v_cvt_pk_bf16_f32 v50, v108, v109
  v_cvt_pk_bf16_f32 v51, v110, v111
  s_waitcnt vmcnt(8)
  v_cvt_f32_i32 v96, v96
  v_cvt_f32_i32 v97, v97
  v_cvt_f32_i32 v98, v98
  v_cvt_f32_i32 v99, v99
  v_cvt_f32_i32 v100, v100
  v_cvt_f32_i32 v101, v101
  v_cvt_f32_i32 v102, v102
  v_cvt_f32_i32 v103, v103
  v_cvt_pk_bf16_f32 v44, v96, v97
  v_cvt_pk_bf16_f32 v45, v98, v99
  v_cvt_pk_bf16_f32 v46, v100, v101
  v_cvt_pk_bf16_f32 v47, v102, v103
  s_mov_b64 vcc, s[92:93]
  s_nop 0
  v_cndmask_b32_dpp v52, v114, v112, vcc quad_perm:[1,0,3,2] row_mask:0xf bank_mask:0xf
  v_cndmask_b32_dpp v53, v115, v113, vcc quad_perm:[1,0,3,2] row_mask:0xf bank_mask:0xf
  v_cndmask_b32_dpp v56, v122, v120, vcc quad_perm:[1,0,3,2] row_mask:0xf bank_mask:0xf
  v_cndmask_b32_dpp v57, v123, v121, vcc quad_perm:[1,0,3,2] row_mask:0xf bank_mask:0xf
  s_mov_b64 vcc, s[94:95]
  v_cndmask_b32_dpp v54, v112, v114, vcc quad_perm:[1,0,3,2] row_mask:0xf bank_mask:0xf
  v_cndmask_b32_dpp v55, v113, v115, vcc quad_perm:[1,0,3,2] row_mask:0xf bank_mask:0xf
  v_cndmask_b32_dpp v58, v120, v122, vcc quad_perm:[1,0,3,2] row_mask:0xf bank_mask:0xf
  v_cndmask_b32_dpp v59, v121, v123, vcc quad_perm:[1,0,3,2] row_mask:0xf bank_mask:0xf
  buffer_load_dwordx4 v[120:123], v9, s[40:43], s36 offen offset:384 nt
  buffer_load_dwordx4 v[124:127], v9, s[40:43], s36 offen offset:896 nt
  buffer_load_dwordx4 v[112:115], v9, s[40:43], s36 offen offset:256 nt
  buffer_load_dwordx4 v[116:119], v9, s[40:43], s36 offen offset:768 nt
  buffer_load_dwordx4 v[104:107], v1, s[40:43], s36 offen offset:128 nt
  buffer_load_dwordx4 v[108:111], v1, s[40:43], s36 offen offset:192 nt
  buffer_load_dwordx4 v[96:99], v1, s[40:43], s36 offen offset:0 nt
  buffer_load_dwordx4 v[100:103], v1, s[40:43], s36 offen offset:64 nt
  s_add_u32 s36, s36, 32768
  s_waitcnt lgkmcnt(0)
  v_mfma_f32_16x16x32_bf16 v[10:13], v[44:47], v[28:31], 0
  v_mfma_f32_16x16x32_bf16 v[10:13], v[48:51], v[32:35], v[10:13]
  v_mfma_f32_16x16x32_bf16 v[10:13], v[52:55], v[36:39], v[10:13]
  v_mfma_f32_16x16x32_bf16 v[10:13], v[56:59], v[40:43], v[10:13]
  s_nop 7
  s_nop 1
  v_cndmask_b32 v20, v10, v11, s[68:69]
  v_cndmask_b32 v21, v12, v13, s[68:69]
  v_cndmask_b32 v20, v20, v21, s[60:61]
  v_sub_f32 v20, v20, v8
  ds_write_b32 v19, v20 offset:0
  v_max_f32 v6, v6, v20
  s_waitcnt vmcnt(14)
  v_cvt_f32_i32 v152, v152
  v_cvt_f32_i32 v153, v153
  v_cvt_f32_i32 v154, v154
  v_cvt_f32_i32 v155, v155
  v_cvt_f32_i32 v156, v156
  v_cvt_f32_i32 v157, v157
  v_cvt_f32_i32 v158, v158
  v_cvt_f32_i32 v159, v159
  v_cvt_pk_bf16_f32 v152, v152, v153
  v_cvt_pk_bf16_f32 v153, v154, v155
  v_cvt_pk_bf16_f32 v154, v156, v157
  v_cvt_pk_bf16_f32 v155, v158, v159
  s_waitcnt vmcnt(12)
  v_cvt_f32_i32 v144, v144
  v_cvt_f32_i32 v145, v145
  v_cvt_f32_i32 v146, v146
  v_cvt_f32_i32 v147, v147
  v_cvt_f32_i32 v148, v148
  v_cvt_f32_i32 v149, v149
  v_cvt_f32_i32 v150, v150
  v_cvt_f32_i32 v151, v151
  v_cvt_pk_bf16_f32 v144, v144, v145
  v_cvt_pk_bf16_f32 v145, v146, v147
  v_cvt_pk_bf16_f32 v146, v148, v149
  v_cvt_pk_bf16_f32 v147, v150, v151
  s_waitcnt vmcnt(10)
  v_cvt_f32_i32 v136, v136
  v_cvt_f32_i32 v137, v137
  v_cvt_f32_i32 v138, v138
  v_cvt_f32_i32 v139, v139
  v_cvt_f32_i32 v140, v140
  v_cvt_f32_i32 v141, v141
  v_cvt_f32_i32 v142, v142
  v_cvt_f32_i32 v143, v143
  v_cvt_pk_bf16_f32 v48, v136, v137
  v_cvt_pk_bf16_f32 v49, v138, v139
  v_cvt_pk_bf16_f32 v50, v140, v141
  v_cvt_pk_bf16_f32 v51, v142, v143
  s_waitcnt vmcnt(8)
  v_cvt_f32_i32 v128, v128
  v_cvt_f32_i32 v129, v129
  v_cvt_f32_i32 v130, v130
  v_cvt_f32_i32 v131, v131
  v_cvt_f32_i32 v132, v132
  v_cvt_f32_i32 v133, v133
  v_cvt_f32_i32 v134, v134
  v_cvt_f32_i32 v135, v135
  v_cvt_pk_bf16_f32 v44, v128, v129
  v_cvt_pk_bf16_f32 v45, v130, v131
  v_cvt_pk_bf16_f32 v46, v132, v133
  v_cvt_pk_bf16_f32 v47, v134, v135
  s_mov_b64 vcc, s[92:93]
  s_nop 0
  v_cndmask_b32_dpp v52, v146, v144, vcc quad_perm:[1,0,3,2] row_mask:0xf bank_mask:0xf
  v_cndmask_b32_dpp v53, v147, v145, vcc quad_perm:[1,0,3,2] row_mask:0xf bank_mask:0xf
  v_cndmask_b32_dpp v56, v154, v152, vcc quad_perm:[1,0,3,2] row_mask:0xf bank_mask:0xf
  v_cndmask_b32_dpp v57, v155, v153, vcc quad_perm:[1,0,3,2] row_mask:0xf bank_mask:0xf
  s_mov_b64 vcc, s[94:95]
  v_cndmask_b32_dpp v54, v144, v146, vcc quad_perm:[1,0,3,2] row_mask:0xf bank_mask:0xf
  v_cndmask_b32_dpp v55, v145, v147, vcc quad_perm:[1,0,3,2] row_mask:0xf bank_mask:0xf
  v_cndmask_b32_dpp v58, v152, v154, vcc quad_perm:[1,0,3,2] row_mask:0xf bank_mask:0xf
  v_cndmask_b32_dpp v59, v153, v155, vcc quad_perm:[1,0,3,2] row_mask:0xf bank_mask:0xf
  buffer_load_dwordx4 v[152:155], v9, s[40:43], s36 offen offset:384 nt
  buffer_load_dwordx4 v[156:159], v9, s[40:43], s36 offen offset:896 nt
  buffer_load_dwordx4 v[144:147], v9, s[40:43], s36 offen offset:256 nt
  buffer_load_dwordx4 v[148:151], v9, s[40:43], s36 offen offset:768 nt
  buffer_load_dwordx4 v[136:139], v1, s[40:43], s36 offen offset:128 nt
  buffer_load_dwordx4 v[140:143], v1, s[40:43], s36 offen offset:192 nt
  buffer_load_dwordx4 v[128:131], v1, s[40:43], s36 offen offset:0 nt
  buffer_load_dwordx4 v[132:135], v1, s[40:43], s36 offen offset:64 nt
  s_add_u32 s36, s36, 32768
  s_waitcnt lgkmcnt(0)
  v_mfma_f32_16x16x32_bf16 v[10:13], v[44:47], v[28:31], 0
  v_mfma_f32_16x16x32_bf16 v[10:13], v[48:51], v[32:35], v[10:13]
  v_mfma_f32_16x16x32_bf16 v[10:13], v[52:55], v[36:39], v[10:13]
  v_mfma_f32_16x16x32_bf16 v[10:13], v[56:59], v[40:43], v[10:13]
  s_nop 7
  s_nop 1
  v_cndmask_b32 v20, v10, v11, s[68:69]
  v_cndmask_b32 v21, v12, v13, s[68:69]
  v_cndmask_b32 v20, v20, v21, s[60:61]
  v_sub_f32 v20, v20, v8
  ds_write_b32 v19, v20 offset:256
  v_max_f32 v6, v6, v20
  ds_read_b128 v[28:31], v3 offset:0
  ds_read_b128 v[32:35], v3 offset:256
  ds_read_b128 v[36:39], v3 offset:512
  ds_read_b128 v[40:43], v3 offset:768
  ds_read_b32 v8, v4
  v_add_u32 v3, 1024, v3
  v_add_u32 v4, 16, v4
  v_add_u32 v19, 512, v19
  s_sub_u32 s77, s77, 1
  s_cmp_lg_u32 s77, 0
  s_cbranch_scc1 L_loopK
  s_waitcnt vmcnt(14)
  v_cvt_f32_i32 v120, v120
  v_cvt_f32_i32 v121, v121
  v_cvt_f32_i32 v122, v122
  v_cvt_f32_i32 v123, v123
  v_cvt_f32_i32 v124, v124
  v_cvt_f32_i32 v125, v125
  v_cvt_f32_i32 v126, v126
  v_cvt_f32_i32 v127, v127
  v_cvt_pk_bf16_f32 v120, v120, v121
  v_cvt_pk_bf16_f32 v121, v122, v123
  v_cvt_pk_bf16_f32 v122, v124, v125
  v_cvt_pk_bf16_f32 v123, v126, v127
  s_waitcnt vmcnt(12)
  v_cvt_f32_i32 v112, v112
  v_cvt_f32_i32 v113, v113
  v_cvt_f32_i32 v114, v114
  v_cvt_f32_i32 v115, v115
  v_cvt_f32_i32 v116, v116
  v_cvt_f32_i32 v117, v117
  v_cvt_f32_i32 v118, v118
  v_cvt_f32_i32 v119, v119
  v_cvt_pk_bf16_f32 v112, v112, v113
  v_cvt_pk_bf16_f32 v113, v114, v115
  v_cvt_pk_bf16_f32 v114, v116, v117
  v_cvt_pk_bf16_f32 v115, v118, v119
  s_waitcnt vmcnt(10)
  v_cvt_f32_i32 v104, v104
  v_cvt_f32_i32 v105, v105
  v_cvt_f32_i32 v106, v106
  v_cvt_f32_i32 v107, v107
  v_cvt_f32_i32 v108, v108
  v_cvt_f32_i32 v109, v109
  v_cvt_f32_i32 v110, v110
  v_cvt_f32_i32 v111, v111
  v_cvt_pk_bf16_f32 v48, v104, v105
  v_cvt_pk_bf16_f32 v49, v106, v107
  v_cvt_pk_bf16_f32 v50, v108, v109
  v_cvt_pk_bf16_f32 v51, v110, v111
  s_waitcnt vmcnt(8)
  v_cvt_f32_i32 v96, v96
  v_cvt_f32_i32 v97, v97
  v_cvt_f32_i32 v98, v98
  v_cvt_f32_i32 v99, v99
  v_cvt_f32_i32 v100, v100
  v_cvt_f32_i32 v101, v101
  v_cvt_f32_i32 v102, v102
  v_cvt_f32_i32 v103, v103
  v_cvt_pk_bf16_f32 v44, v96, v97
  v_cvt_pk_bf16_f32 v45, v98, v99
  v_cvt_pk_bf16_f32 v46, v100, v101
  v_cvt_pk_bf16_f32 v47, v102, v103
  s_mov_b64 vcc, s[92:93]
  s_nop 0
  v_cndmask_b32_dpp v52, v114, v112, vcc quad_perm:[1,0,3,2] row_mask:0xf bank_mask:0xf
  v_cndmask_b32_dpp v53, v115, v113, vcc quad_perm:[1,0,3,2] row_mask:0xf bank_mask:0xf
  v_cndmask_b32_dpp v56, v122, v120, vcc quad_perm:[1,0,3,2] row_mask:0xf bank_mask:0xf
  v_cndmask_b32_dpp v57, v123, v121, vcc quad_perm:[1,0,3,2] row_mask:0xf bank_mask:0xf
  s_mov_b64 vcc, s[94:95]
  v_cndmask_b32_dpp v54, v112, v114, vcc quad_perm:[1,0,3,2] row_mask:0xf bank_mask:0xf
  v_cndmask_b32_dpp v55, v113, v115, vcc quad_perm:[1,0,3,2] row_mask:0xf bank_mask:0xf
  v_cndmask_b32_dpp v58, v120, v122, vcc quad_perm:[1,0,3,2] row_mask:0xf bank_mask:0xf
  v_cndmask_b32_dpp v59, v121, v123, vcc quad_perm:[1,0,3,2] row_mask:0xf bank_mask:0xf
  buffer_load_dwordx2 v[96:97], v2, s[44:47], s32 offen offset:0 nt
  buffer_load_dwordx2 v[98:99], v2, s[44:47], s32 offen offset:128 nt
  buffer_load_dwordx2 v[100:101], v2, s[44:47], s32 offen offset:256 nt
  buffer_load_dwordx2 v[102:103], v2, s[44:47], s32 offen offset:384 nt
  buffer_load_dwordx2 v[104:105], v2, s[44:47], s32 offen offset:512 nt
  buffer_load_dwordx2 v[106:107], v2, s[44:47], s32 offen offset:640 nt
  buffer_load_dwordx2 v[108:109], v2, s[44:47], s32 offen offset:768 nt
  buffer_load_dwordx2 v[110:111], v2, s[44:47], s32 offen offset:896 nt
  buffer_load_dwordx2 v[112:113], v2, s[44:47], s32 offen offset:1024 nt
  buffer_load_dwordx2 v[114:115], v2, s[44:47], s32 offen offset:1152 nt
  buffer_load_dwordx2 v[116:117], v2, s[44:47], s32 offen offset:1280 nt
  buffer_load_dwordx2 v[118:119], v2, s[44:47], s32 offen offset:1408 nt
  buffer_load_dwordx2 v[120:121], v2, s[44:47], s32 offen offset:1536 nt
  buffer_load_dwordx2 v[122:123], v2, s[44:47], s32 offen offset:1664 nt
  buffer_load_dwordx2 v[124:125], v2, s[44:47], s32 offen offset:1792 nt
  buffer_load_dwordx2 v[126:127], v2, s[44:47], s32 offen offset:1920 nt
  s_add_u32 s32, s32, 32768
  s_waitcnt lgkmcnt(0)
  v_mfma_f32_16x16x32_bf16 v[10:13], v[44:47], v[28:31], 0
  v_mfma_f32_16x16x32_bf16 v[10:13], v[48:51], v[32:35], v[10:13]
  v_mfma_f32_16x16x32_bf16 v[10:13], v[52:55], v[36:39], v[10:13]
  v_mfma_f32_16x16x32_bf16 v[10:13], v[56:59], v[40:43], v[10:13]
  s_nop 7
  s_nop 1
  v_cndmask_b32 v20, v10, v11, s[68:69]
  v_cndmask_b32 v21, v12, v13, s[68:69]
  v_cndmask_b32 v20, v20, v21, s[60:61]
  v_sub_f32 v20, v20, v8
  ds_write_b32 v19, v20 offset:0
  v_max_f32 v6, v6, v20
  s_waitcnt vmcnt(22)
  v_cvt_f32_i32 v152, v152
  v_cvt_f32_i32 v153, v153
  v_cvt_f32_i32 v154, v154
  v_cvt_f32_i32 v155, v155
  v_cvt_f32_i32 v156, v156
  v_cvt_f32_i32 v157, v157
  v_cvt_f32_i32 v158, v158
  v_cvt_f32_i32 v159, v159
  v_cvt_pk_bf16_f32 v152, v152, v153
  v_cvt_pk_bf16_f32 v153, v154, v155
  v_cvt_pk_bf16_f32 v154, v156, v157
  v_cvt_pk_bf16_f32 v155, v158, v159
  s_waitcnt vmcnt(20)
  v_cvt_f32_i32 v144, v144
  v_cvt_f32_i32 v145, v145
  v_cvt_f32_i32 v146, v146
  v_cvt_f32_i32 v147, v147
  v_cvt_f32_i32 v148, v148
  v_cvt_f32_i32 v149, v149
  v_cvt_f32_i32 v150, v150
  v_cvt_f32_i32 v151, v151
  v_cvt_pk_bf16_f32 v144, v144, v145
  v_cvt_pk_bf16_f32 v145, v146, v147
  v_cvt_pk_bf16_f32 v146, v148, v149
  v_cvt_pk_bf16_f32 v147, v150, v151
  s_waitcnt vmcnt(18)
  v_cvt_f32_i32 v136, v136
  v_cvt_f32_i32 v137, v137
  v_cvt_f32_i32 v138, v138
  v_cvt_f32_i32 v139, v139
  v_cvt_f32_i32 v140, v140
  v_cvt_f32_i32 v141, v141
  v_cvt_f32_i32 v142, v142
  v_cvt_f32_i32 v143, v143
  v_cvt_pk_bf16_f32 v48, v136, v137
  v_cvt_pk_bf16_f32 v49, v138, v139
  v_cvt_pk_bf16_f32 v50, v140, v141
  v_cvt_pk_bf16_f32 v51, v142, v143
  s_waitcnt vmcnt(16)
  v_cvt_f32_i32 v128, v128
  v_cvt_f32_i32 v129, v129
  v_cvt_f32_i32 v130, v130
  v_cvt_f32_i32 v131, v131
  v_cvt_f32_i32 v132, v132
  v_cvt_f32_i32 v133, v133
  v_cvt_f32_i32 v134, v134
  v_cvt_f32_i32 v135, v135
  v_cvt_pk_bf16_f32 v44, v128, v129
  v_cvt_pk_bf16_f32 v45, v130, v131
  v_cvt_pk_bf16_f32 v46, v132, v133
  v_cvt_pk_bf16_f32 v47, v134, v135
  s_mov_b64 vcc, s[92:93]
  s_nop 0
  v_cndmask_b32_dpp v52, v146, v144, vcc quad_perm:[1,0,3,2] row_mask:0xf bank_mask:0xf
  v_cndmask_b32_dpp v53, v147, v145, vcc quad_perm:[1,0,3,2] row_mask:0xf bank_mask:0xf
  v_cndmask_b32_dpp v56, v154, v152, vcc quad_perm:[1,0,3,2] row_mask:0xf bank_mask:0xf
  v_cndmask_b32_dpp v57, v155, v153, vcc quad_perm:[1,0,3,2] row_mask:0xf bank_mask:0xf
  s_mov_b64 vcc, s[94:95]
  v_cndmask_b32_dpp v54, v144, v146, vcc quad_perm:[1,0,3,2] row_mask:0xf bank_mask:0xf
  v_cndmask_b32_dpp v55, v145, v147, vcc quad_perm:[1,0,3,2] row_mask:0xf bank_mask:0xf
  v_cndmask_b32_dpp v58, v152, v154, vcc quad_perm:[1,0,3,2] row_mask:0xf bank_mask:0xf
  v_cndmask_b32_dpp v59, v153, v155, vcc quad_perm:[1,0,3,2] row_mask:0xf bank_mask:0xf
  buffer_load_dwordx2 v[128:129], v2, s[44:47], s32 offen offset:0 nt
  buffer_load_dwordx2 v[130:131], v2, s[44:47], s32 offen offset:128 nt
  buffer_load_dwordx2 v[132:133], v2, s[44:47], s32 offen offset:256 nt
  buffer_load_dwordx2 v[134:135], v2, s[44:47], s32 offen offset:384 nt
  buffer_load_dwordx2 v[136:137], v2, s[44:47], s32 offen offset:512 nt
  buffer_load_dwordx2 v[138:139], v2, s[44:47], s32 offen offset:640 nt
  buffer_load_dwordx2 v[140:141], v2, s[44:47], s32 offen offset:768 nt
  buffer_load_dwordx2 v[142:143], v2, s[44:47], s32 offen offset:896 nt
  buffer_load_dwordx2 v[144:145], v2, s[44:47], s32 offen offset:1024 nt
  buffer_load_dwordx2 v[146:147], v2, s[44:47], s32 offen offset:1152 nt
  buffer_load_dwordx2 v[148:149], v2, s[44:47], s32 offen offset:1280 nt
  buffer_load_dwordx2 v[150:151], v2, s[44:47], s32 offen offset:1408 nt
  buffer_load_dwordx2 v[152:153], v2, s[44:47], s32 offen offset:1536 nt
  buffer_load_dwordx2 v[154:155], v2, s[44:47], s32 offen offset:1664 nt
  buffer_load_dwordx2 v[156:157], v2, s[44:47], s32 offen offset:1792 nt
  buffer_load_dwordx2 v[158:159], v2, s[44:47], s32 offen offset:1920 nt
  s_add_u32 s32, s32, 32768
  s_waitcnt lgkmcnt(0)
  v_mfma_f32_16x16x32_bf16 v[10:13], v[44:47], v[28:31], 0
  v_mfma_f32_16x16x32_bf16 v[10:13], v[48:51], v[32:35], v[10:13]
  v_mfma_f32_16x16x32_bf16 v[10:13], v[52:55], v[36:39], v[10:13]
  v_mfma_f32_16x16x32_bf16 v[10:13], v[56:59], v[40:43], v[10:13]
  s_nop 7
  s_nop 1
  v_cndmask_b32 v20, v10, v11, s[68:69]
  v_cndmask_b32 v21, v12, v13, s[68:69]
  v_cndmask_b32 v20, v20, v21, s[60:61]
  v_sub_f32 v20, v20, v8
  ds_write_b32 v19, v20 offset:256
  v_max_f32 v6, v6, v20
  v_subrev_u32 v19, 7680, v19
  s_nop 1
  v_max_f32_dpp v6, v6, v6 row_ror:4 row_mask:0xf bank_mask:0xf
  s_nop 1
  v_max_f32_dpp v6, v6, v6 row_ror:8 row_mask:0xf bank_mask:0xf
  v_mov_b32 v27, v6
  s_nop 1
  v_permlane16_swap_b32 v6, v27
  v_max_f32 v6, v6, v27
  v_mov_b32 v27, v6
  s_nop 1
  v_permlane32_swap_b32 v6, v27
  v_max_f32 v6, v6, v27
  s_barrier
  v_and_b32 v20, 15, v0
  v_lshl_add_u32 v4, v20, 3, v2
  s_mov_b32 s77, 13
L_loopV:
  ds_read_b32 v20, v19 offset:0
  ds_read_u16 v21, v5 offset:0
  ds_read_b64 v[16:17], v18 offset:4096
  s_waitcnt vmcnt(28)
  v_cvt_f32_i32 v96, v96
  v_cvt_f32_i32 v97, v97
  v_cvt_f32_i32 v98, v98
  v_cvt_f32_i32 v99, v99
  v_cvt_f32_i32 v100, v100
  v_cvt_f32_i32 v101, v101
  v_cvt_f32_i32 v102, v102
  v_cvt_f32_i32 v103, v103
  s_waitcnt vmcnt(24)
  v_cvt_f32_i32 v104, v104
  v_cvt_f32_i32 v105, v105
  v_cvt_f32_i32 v106, v106
  v_cvt_f32_i32 v107, v107
  v_cvt_f32_i32 v108, v108
  v_cvt_f32_i32 v109, v109
  v_cvt_f32_i32 v110, v110
  v_cvt_f32_i32 v111, v111
  v_cvt_pk_bf16_f32 v44, v96, v104
  v_cvt_pk_bf16_f32 v46, v97, v105
  v_cvt_pk_bf16_f32 v48, v98, v106
  v_cvt_pk_bf16_f32 v50, v99, v107
  v_cvt_pk_bf16_f32 v52, v100, v108
  v_cvt_pk_bf16_f32 v54, v101, v109
  v_cvt_pk_bf16_f32 v56, v102, v110
  v_cvt_pk_bf16_f32 v58, v103, v111
  s_waitcnt lgkmcnt(0)
  v_sub_f32 v20, v20, v6
  v_exp_f32 v20, v20
  v_lshlrev_b32 v21, 16, v21
  v_mul_f32 v21, v21, v20
  v_add_f32 v7, v7, v20
  s_nop 0
  v_mov_b32_dpp v20, v21 row_ror:12 row_mask:0xf bank_mask:0xf
  v_cvt_pk_bf16_f32 v14, v21, v20
  s_nop 1
  v_mov_b32_dpp v15, v14 row_ror:8 row_mask:0xf bank_mask:0xf
  s_waitcnt vmcnt(20)
  v_cvt_f32_i32 v112, v112
  v_cvt_f32_i32 v113, v113
  v_cvt_f32_i32 v114, v114
  v_cvt_f32_i32 v115, v115
  v_cvt_f32_i32 v116, v116
  v_cvt_f32_i32 v117, v117
  v_cvt_f32_i32 v118, v118
  v_cvt_f32_i32 v119, v119
  s_waitcnt vmcnt(16)
  v_cvt_f32_i32 v120, v120
  v_cvt_f32_i32 v121, v121
  v_cvt_f32_i32 v122, v122
  v_cvt_f32_i32 v123, v123
  v_cvt_f32_i32 v124, v124
  v_cvt_f32_i32 v125, v125
  v_cvt_f32_i32 v126, v126
  v_cvt_f32_i32 v127, v127
  v_cvt_pk_bf16_f32 v45, v112, v120
  v_cvt_pk_bf16_f32 v47, v113, v121
  v_cvt_pk_bf16_f32 v49, v114, v122
  v_cvt_pk_bf16_f32 v51, v115, v123
  v_cvt_pk_bf16_f32 v53, v116, v124
  v_cvt_pk_bf16_f32 v55, v117, v125
  v_cvt_pk_bf16_f32 v57, v118, v126
  v_cvt_pk_bf16_f32 v59, v119, v127
  buffer_load_dwordx2 v[96:97], v2, s[44:47], s32 offen offset:0 nt
  buffer_load_dwordx2 v[98:99], v2, s[44:47], s32 offen offset:128 nt
  buffer_load_dwordx2 v[100:101], v2, s[44:47], s32 offen offset:256 nt
  buffer_load_dwordx2 v[102:103], v2, s[44:47], s32 offen offset:384 nt
  buffer_load_dwordx2 v[104:105], v2, s[44:47], s32 offen offset:512 nt
  buffer_load_dwordx2 v[106:107], v2, s[44:47], s32 offen offset:640 nt
  buffer_load_dwordx2 v[108:109], v2, s[44:47], s32 offen offset:768 nt
  buffer_load_dwordx2 v[110:111], v2, s[44:47], s32 offen offset:896 nt
  buffer_load_dwordx2 v[112:113], v2, s[44:47], s32 offen offset:1024 nt
  buffer_load_dwordx2 v[114:115], v2, s[44:47], s32 offen offset:1152 nt
  buffer_load_dwordx2 v[116:117], v2, s[44:47], s32 offen offset:1280 nt
  buffer_load_dwordx2 v[118:119], v2, s[44:47], s32 offen offset:1408 nt
  buffer_load_dwordx2 v[120:121], v2, s[44:47], s32 offen offset:1536 nt
  buffer_load_dwordx2 v[122:123], v2, s[44:47], s32 offen offset:1664 nt
  buffer_load_dwordx2 v[124:125], v2, s[44:47], s32 offen offset:1792 nt
  buffer_load_dwordx2 v[126:127], v2, s[44:47], s32 offen offset:1920 nt
  s_add_u32 s32, s32, 32768
  v_mfma_f32_16x16x16_bf16 v[92:95], v[16:17], v[14:15], v[92:95]
  v_mfma_f32_16x16x16_bf16 v[60:63], v[44:45], v[14:15], v[60:63]
  v_mfma_f32_16x16x16_bf16 v[64:67], v[46:47], v[14:15], v[64:67]
  v_mfma_f32_16x16x16_bf16 v[68:71], v[48:49], v[14:15], v[68:71]
  v_mfma_f32_16x16x16_bf16 v[72:75], v[50:51], v[14:15], v[72:75]
  v_mfma_f32_16x16x16_bf16 v[76:79], v[52:53], v[14:15], v[76:79]
  v_mfma_f32_16x16x16_bf16 v[80:83], v[54:55], v[14:15], v[80:83]
  v_mfma_f32_16x16x16_bf16 v[84:87], v[56:57], v[14:15], v[84:87]
  v_mfma_f32_16x16x16_bf16 v[88:91], v[58:59], v[14:15], v[88:91]
  ds_read_b32 v20, v19 offset:256
  ds_read_u16 v21, v5 offset:128
  ds_read_b64 v[16:17], v18 offset:4224
  s_waitcnt vmcnt(28)
  v_cvt_f32_i32 v128, v128
  v_cvt_f32_i32 v129, v129
  v_cvt_f32_i32 v130, v130
  v_cvt_f32_i32 v131, v131
  v_cvt_f32_i32 v132, v132
  v_cvt_f32_i32 v133, v133
  v_cvt_f32_i32 v134, v134
  v_cvt_f32_i32 v135, v135
  s_waitcnt vmcnt(24)
  v_cvt_f32_i32 v136, v136
  v_cvt_f32_i32 v137, v137
  v_cvt_f32_i32 v138, v138
  v_cvt_f32_i32 v139, v139
  v_cvt_f32_i32 v140, v140
  v_cvt_f32_i32 v141, v141
  v_cvt_f32_i32 v142, v142
  v_cvt_f32_i32 v143, v143
  v_cvt_pk_bf16_f32 v44, v128, v136
  v_cvt_pk_bf16_f32 v46, v129, v137
  v_cvt_pk_bf16_f32 v48, v130, v138
  v_cvt_pk_bf16_f32 v50, v131, v139
  v_cvt_pk_bf16_f32 v52, v132, v140
  v_cvt_pk_bf16_f32 v54, v133, v141
  v_cvt_pk_bf16_f32 v56, v134, v142
  v_cvt_pk_bf16_f32 v58, v135, v143
  s_waitcnt lgkmcnt(0)
  v_sub_f32 v20, v20, v6
  v_exp_f32 v20, v20
  v_lshlrev_b32 v21, 16, v21
  v_mul_f32 v21, v21, v20
  v_add_f32 v7, v7, v20
  s_nop 0
  v_mov_b32_dpp v20, v21 row_ror:12 row_mask:0xf bank_mask:0xf
  v_cvt_pk_bf16_f32 v14, v21, v20
  s_nop 1
  v_mov_b32_dpp v15, v14 row_ror:8 row_mask:0xf bank_mask:0xf
  s_waitcnt vmcnt(20)
  v_cvt_f32_i32 v144, v144
  v_cvt_f32_i32 v145, v145
  v_cvt_f32_i32 v146, v146
  v_cvt_f32_i32 v147, v147
  v_cvt_f32_i32 v148, v148
  v_cvt_f32_i32 v149, v149
  v_cvt_f32_i32 v150, v150
  v_cvt_f32_i32 v151, v151
  s_waitcnt vmcnt(16)
  v_cvt_f32_i32 v152, v152
  v_cvt_f32_i32 v153, v153
  v_cvt_f32_i32 v154, v154
  v_cvt_f32_i32 v155, v155
  v_cvt_f32_i32 v156, v156
  v_cvt_f32_i32 v157, v157
  v_cvt_f32_i32 v158, v158
  v_cvt_f32_i32 v159, v159
  v_cvt_pk_bf16_f32 v45, v144, v152
  v_cvt_pk_bf16_f32 v47, v145, v153
  v_cvt_pk_bf16_f32 v49, v146, v154
  v_cvt_pk_bf16_f32 v51, v147, v155
  v_cvt_pk_bf16_f32 v53, v148, v156
  v_cvt_pk_bf16_f32 v55, v149, v157
  v_cvt_pk_bf16_f32 v57, v150, v158
  v_cvt_pk_bf16_f32 v59, v151, v159
  buffer_load_dwordx2 v[128:129], v2, s[44:47], s32 offen offset:0 nt
  buffer_load_dwordx2 v[130:131], v2, s[44:47], s32 offen offset:128 nt
  buffer_load_dwordx2 v[132:133], v2, s[44:47], s32 offen offset:256 nt
  buffer_load_dwordx2 v[134:135], v2, s[44:47], s32 offen offset:384 nt
  buffer_load_dwordx2 v[136:137], v2, s[44:47], s32 offen offset:512 nt
  buffer_load_dwordx2 v[138:139], v2, s[44:47], s32 offen offset:640 nt
  buffer_load_dwordx2 v[140:141], v2, s[44:47], s32 offen offset:768 nt
  buffer_load_dwordx2 v[142:143], v2, s[44:47], s32 offen offset:896 nt
  buffer_load_dwordx2 v[144:145], v2, s[44:47], s32 offen offset:1024 nt
  buffer_load_dwordx2 v[146:147], v2, s[44:47], s32 offen offset:1152 nt
  buffer_load_dwordx2 v[148:149], v2, s[44:47], s32 offen offset:1280 nt
  buffer_load_dwordx2 v[150:151], v2, s[44:47], s32 offen offset:1408 nt
  buffer_load_dwordx2 v[152:153], v2, s[44:47], s32 offen offset:1536 nt
  buffer_load_dwordx2 v[154:155], v2, s[44:47], s32 offen offset:1664 nt
  buffer_load_dwordx2 v[156:157], v2, s[44:47], s32 offen offset:1792 nt
  buffer_load_dwordx2 v[158:159], v2, s[44:47], s32 offen offset:1920 nt
  s_add_u32 s32, s32, 32768
  v_mfma_f32_16x16x16_bf16 v[92:95], v[16:17], v[14:15], v[92:95]
  v_mfma_f32_16x16x16_bf16 v[60:63], v[44:45], v[14:15], v[60:63]
  v_mfma_f32_16x16x16_bf16 v[64:67], v[46:47], v[14:15], v[64:67]
  v_mfma_f32_16x16x16_bf16 v[68:71], v[48:49], v[14:15], v[68:71]
  v_mfma_f32_16x16x16_bf16 v[72:75], v[50:51], v[14:15], v[72:75]
  v_mfma_f32_16x16x16_bf16 v[76:79], v[52:53], v[14:15], v[76:79]
  v_mfma_f32_16x16x16_bf16 v[80:83], v[54:55], v[14:15], v[80:83]
  v_mfma_f32_16x16x16_bf16 v[84:87], v[56:57], v[14:15], v[84:87]
  v_mfma_f32_16x16x16_bf16 v[88:91], v[58:59], v[14:15], v[88:91]
  v_add_u32 v19, 512, v19
  v_add_u32 v5, 256, v5
  v_add_u32 v18, 256, v18
  s_sub_u32 s77, s77, 1
  s_cmp_lg_u32 s77, 0
  s_cbranch_scc1 L_loopV
  ds_read_b32 v20, v19 offset:0
  ds_read_u16 v21, v5 offset:0
  ds_read_b64 v[16:17], v18 offset:4096
  s_waitcnt vmcnt(28)
  v_cvt_f32_i32 v96, v96
  v_cvt_f32_i32 v97, v97
  v_cvt_f32_i32 v98, v98
  v_cvt_f32_i32 v99, v99
  v_cvt_f32_i32 v100, v100
  v_cvt_f32_i32 v101, v101
  v_cvt_f32_i32 v102, v102
  v_cvt_f32_i32 v103, v103
  s_waitcnt vmcnt(24)
  v_cvt_f32_i32 v104, v104
  v_cvt_f32_i32 v105, v105
  v_cvt_f32_i32 v106, v106
  v_cvt_f32_i32 v107, v107
  v_cvt_f32_i32 v108, v108
  v_cvt_f32_i32 v109, v109
  v_cvt_f32_i32 v110, v110
  v_cvt_f32_i32 v111, v111
  v_cvt_pk_bf16_f32 v44, v96, v104
  v_cvt_pk_bf16_f32 v46, v97, v105
  v_cvt_pk_bf16_f32 v48, v98, v106
  v_cvt_pk_bf16_f32 v50, v99, v107
  v_cvt_pk_bf16_f32 v52, v100, v108
  v_cvt_pk_bf16_f32 v54, v101, v109
  v_cvt_pk_bf16_f32 v56, v102, v110
  v_cvt_pk_bf16_f32 v58, v103, v111
  s_waitcnt lgkmcnt(0)
  v_sub_f32 v20, v20, v6
  v_exp_f32 v20, v20
  v_lshlrev_b32 v21, 16, v21
  v_mul_f32 v21, v21, v20
  v_add_f32 v7, v7, v20
  s_nop 0
  v_mov_b32_dpp v20, v21 row_ror:12 row_mask:0xf bank_mask:0xf
  v_cvt_pk_bf16_f32 v14, v21, v20
  s_nop 1
  v_mov_b32_dpp v15, v14 row_ror:8 row_mask:0xf bank_mask:0xf
  s_waitcnt vmcnt(20)
  v_cvt_f32_i32 v112, v112
  v_cvt_f32_i32 v113, v113
  v_cvt_f32_i32 v114, v114
  v_cvt_f32_i32 v115, v115
  v_cvt_f32_i32 v116, v116
  v_cvt_f32_i32 v117, v117
  v_cvt_f32_i32 v118, v118
  v_cvt_f32_i32 v119, v119
  s_waitcnt vmcnt(16)
  v_cvt_f32_i32 v120, v120
  v_cvt_f32_i32 v121, v121
  v_cvt_f32_i32 v122, v122
  v_cvt_f32_i32 v123, v123
  v_cvt_f32_i32 v124, v124
  v_cvt_f32_i32 v125, v125
  v_cvt_f32_i32 v126, v126
  v_cvt_f32_i32 v127, v127
  v_cvt_pk_bf16_f32 v45, v112, v120
  v_cvt_pk_bf16_f32 v47, v113, v121
  v_cvt_pk_bf16_f32 v49, v114, v122
  v_cvt_pk_bf16_f32 v51, v115, v123
  v_cvt_pk_bf16_f32 v53, v116, v124
  v_cvt_pk_bf16_f32 v55, v117, v125
  v_cvt_pk_bf16_f32 v57, v118, v126
  v_cvt_pk_bf16_f32 v59, v119, v127
  buffer_load_dwordx4 v[96:99], v4, s[44:47], s32 offen offset:0 nt
  buffer_load_dwordx4 v[100:103], v4, s[44:47], s32 offen offset:256 nt
  buffer_load_dwordx4 v[104:107], v4, s[44:47], s32 offen offset:512 nt
  buffer_load_dwordx4 v[108:111], v4, s[44:47], s32 offen offset:768 nt
  buffer_load_dwordx4 v[112:115], v4, s[44:47], s32 offen offset:1024 nt
  buffer_load_dwordx4 v[116:119], v4, s[44:47], s32 offen offset:1280 nt
  buffer_load_dwordx4 v[120:123], v4, s[44:47], s32 offen offset:1536 nt
  buffer_load_dwordx4 v[124:127], v4, s[44:47], s32 offen offset:1792 nt
  s_add_u32 s32, s32, 32768
  v_mfma_f32_16x16x16_bf16 v[92:95], v[16:17], v[14:15], v[92:95]
  v_mfma_f32_16x16x16_bf16 v[60:63], v[44:45], v[14:15], v[60:63]
  v_mfma_f32_16x16x16_bf16 v[64:67], v[46:47], v[14:15], v[64:67]
  v_mfma_f32_16x16x16_bf16 v[68:71], v[48:49], v[14:15], v[68:71]
  v_mfma_f32_16x16x16_bf16 v[72:75], v[50:51], v[14:15], v[72:75]
  v_mfma_f32_16x16x16_bf16 v[76:79], v[52:53], v[14:15], v[76:79]
  v_mfma_f32_16x16x16_bf16 v[80:83], v[54:55], v[14:15], v[80:83]
  v_mfma_f32_16x16x16_bf16 v[84:87], v[56:57], v[14:15], v[84:87]
  v_mfma_f32_16x16x16_bf16 v[88:91], v[58:59], v[14:15], v[88:91]
  ds_read_b32 v20, v19 offset:256
  ds_read_u16 v21, v5 offset:128
  ds_read_b64 v[16:17], v18 offset:4224
  s_waitcnt vmcnt(20)
  v_cvt_f32_i32 v128, v128
  v_cvt_f32_i32 v129, v129
  v_cvt_f32_i32 v130, v130
  v_cvt_f32_i32 v131, v131
  v_cvt_f32_i32 v132, v132
  v_cvt_f32_i32 v133, v133
  v_cvt_f32_i32 v134, v134
  v_cvt_f32_i32 v135, v135
  s_waitcnt vmcnt(16)
  v_cvt_f32_i32 v136, v136
  v_cvt_f32_i32 v137, v137
  v_cvt_f32_i32 v138, v138
  v_cvt_f32_i32 v139, v139
  v_cvt_f32_i32 v140, v140
  v_cvt_f32_i32 v141, v141
  v_cvt_f32_i32 v142, v142
  v_cvt_f32_i32 v143, v143
  v_cvt_pk_bf16_f32 v44, v128, v136
  v_cvt_pk_bf16_f32 v46, v129, v137
  v_cvt_pk_bf16_f32 v48, v130, v138
  v_cvt_pk_bf16_f32 v50, v131, v139
  v_cvt_pk_bf16_f32 v52, v132, v140
  v_cvt_pk_bf16_f32 v54, v133, v141
  v_cvt_pk_bf16_f32 v56, v134, v142
  v_cvt_pk_bf16_f32 v58, v135, v143
  s_waitcnt lgkmcnt(0)
  v_sub_f32 v20, v20, v6
  v_exp_f32 v20, v20
  v_lshlrev_b32 v21, 16, v21
  v_mul_f32 v21, v21, v20
  v_add_f32 v7, v7, v20
  s_nop 0
  v_mov_b32_dpp v20, v21 row_ror:12 row_mask:0xf bank_mask:0xf
  v_cvt_pk_bf16_f32 v14, v21, v20
  s_nop 1
  v_mov_b32_dpp v15, v14 row_ror:8 row_mask:0xf bank_mask:0xf
  s_waitcnt vmcnt(12)
  v_cvt_f32_i32 v144, v144
  v_cvt_f32_i32 v145, v145
  v_cvt_f32_i32 v146, v146
  v_cvt_f32_i32 v147, v147
  v_cvt_f32_i32 v148, v148
  v_cvt_f32_i32 v149, v149
  v_cvt_f32_i32 v150, v150
  v_cvt_f32_i32 v151, v151
  s_waitcnt vmcnt(8)
  v_cvt_f32_i32 v152, v152
  v_cvt_f32_i32 v153, v153
  v_cvt_f32_i32 v154, v154
  v_cvt_f32_i32 v155, v155
  v_cvt_f32_i32 v156, v156
  v_cvt_f32_i32 v157, v157
  v_cvt_f32_i32 v158, v158
  v_cvt_f32_i32 v159, v159
  v_cvt_pk_bf16_f32 v45, v144, v152
  v_cvt_pk_bf16_f32 v47, v145, v153
  v_cvt_pk_bf16_f32 v49, v146, v154
  v_cvt_pk_bf16_f32 v51, v147, v155
  v_cvt_pk_bf16_f32 v53, v148, v156
  v_cvt_pk_bf16_f32 v55, v149, v157
  v_cvt_pk_bf16_f32 v57, v150, v158
  v_cvt_pk_bf16_f32 v59, v151, v159
  buffer_load_dwordx4 v[128:131], v4, s[44:47], s32 offen offset:0 nt
  buffer_load_dwordx4 v[132:135], v4, s[44:47], s32 offen offset:256 nt
  buffer_load_dwordx4 v[136:139], v4, s[44:47], s32 offen offset:512 nt
  buffer_load_dwordx4 v[140:143], v4, s[44:47], s32 offen offset:768 nt
  buffer_load_dwordx4 v[144:147], v4, s[44:47], s32 offen offset:1024 nt
  buffer_load_dwordx4 v[148:151], v4, s[44:47], s32 offen offset:1280 nt
  buffer_load_dwordx4 v[152:155], v4, s[44:47], s32 offen offset:1536 nt
  buffer_load_dwordx4 v[156:159], v4, s[44:47], s32 offen offset:1792 nt
  s_add_u32 s32, s32, 32768
  v_mfma_f32_16x16x16_bf16 v[92:95], v[16:17], v[14:15], v[92:95]
  v_mfma_f32_16x16x16_bf16 v[60:63], v[44:45], v[14:15], v[60:63]
  v_mfma_f32_16x16x16_bf16 v[64:67], v[46:47], v[14:15], v[64:67]
  v_mfma_f32_16x16x16_bf16 v[68:71], v[48:49], v[14:15], v[68:71]
  v_mfma_f32_16x16x16_bf16 v[72:75], v[50:51], v[14:15], v[72:75]
  v_mfma_f32_16x16x16_bf16 v[76:79], v[52:53], v[14:15], v[76:79]
  v_mfma_f32_16x16x16_bf16 v[80:83], v[54:55], v[14:15], v[80:83]
  v_mfma_f32_16x16x16_bf16 v[84:87], v[56:57], v[14:15], v[84:87]
  v_mfma_f32_16x16x16_bf16 v[88:91], v[58:59], v[14:15], v[88:91]
  v_add_u32 v19, 512, v19
  v_add_u32 v5, 256, v5
  v_add_u32 v18, 256, v18
  v_and_b32 v20, 15, v0
  v_lshrrev_b32 v21, 4, v0
  s_lshl_b32 s37, s3, 11
  s_add_u32 s37, s37, 25600
  v_cmp_gt_u32 s[62:63], 4, v20
  v_lshl_add_u32 v22, v20, 9, s37
  v_lshl_add_u32 v23, v21, 6, v22
  v_lshl_add_u32 v22, v21, 5, v22
  s_nop 2
  s_mov_b64 exec, s[62:63]
  ds_write_b32 v22, v60 offset:0
  ds_write_b32 v22, v61 offset:8
  ds_write_b32 v22, v62 offset:16
  ds_write_b32 v22, v63 offset:24
  ds_write_b32 v22, v64 offset:4
  ds_write_b32 v22, v65 offset:12
  ds_write_b32 v22, v66 offset:20
  ds_write_b32 v22, v67 offset:28
  ds_write_b32 v22, v68 offset:128
  ds_write_b32 v22, v69 offset:136
  ds_write_b32 v22, v70 offset:144
  ds_write_b32 v22, v71 offset:152
  ds_write_b32 v22, v72 offset:132
  ds_write_b32 v22, v73 offset:140
  ds_write_b32 v22, v74 offset:148
  ds_write_b32 v22, v75 offset:156
  ds_write_b32 v22, v76 offset:256
  ds_write_b32 v22, v77 offset:264
  ds_write_b32 v22, v78 offset:272
  ds_write_b32 v22, v79 offset:280
  ds_write_b32 v22, v80 offset:260
  ds_write_b32 v22, v81 offset:268
  ds_write_b32 v22, v82 offset:276
  ds_write_b32 v22, v83 offset:284
  ds_write_b32 v22, v84 offset:384
  ds_write_b32 v22, v85 offset:392
  ds_write_b32 v22, v86 offset:400
  ds_write_b32 v22, v87 offset:408
  ds_write_b32 v22, v88 offset:388
  ds_write_b32 v22, v89 offset:396
  ds_write_b32 v22, v90 offset:404
  ds_write_b32 v22, v91 offset:412
  ds_read_b32 v60, v23 offset:0
  ds_read_b32 v61, v23 offset:16
  ds_read_b32 v62, v23 offset:32
  ds_read_b32 v63, v23 offset:48
  ds_read_b32 v64, v23 offset:4
  ds_read_b32 v65, v23 offset:20
  ds_read_b32 v66, v23 offset:36
  ds_read_b32 v67, v23 offset:52
  ds_read_b32 v68, v23 offset:8
  ds_read_b32 v69, v23 offset:24
  ds_read_b32 v70, v23 offset:40
  ds_read_b32 v71, v23 offset:56
  ds_read_b32 v72, v23 offset:12
  ds_read_b32 v73, v23 offset:28
  ds_read_b32 v74, v23 offset:44
  ds_read_b32 v75, v23 offset:60
  ds_read_b32 v76, v23 offset:256
  ds_read_b32 v77, v23 offset:272
  ds_read_b32 v78, v23 offset:288
  ds_read_b32 v79, v23 offset:304
  ds_read_b32 v80, v23 offset:260
  ds_read_b32 v81, v23 offset:276
  ds_read_b32 v82, v23 offset:292
  ds_read_b32 v83, v23 offset:308
  ds_read_b32 v84, v23 offset:264
  ds_read_b32 v85, v23 offset:280
  ds_read_b32 v86, v23 offset:296
  ds_read_b32 v87, v23 offset:312
  ds_read_b32 v88, v23 offset:268
  ds_read_b32 v89, v23 offset:284
  ds_read_b32 v90, v23 offset:300
  ds_read_b32 v91, v23 offset:316
  s_mov_b64 exec, -1
  ds_read_b32 v20, v19 offset:0
  ds_read_u16 v21, v5 offset:0
  ds_read_b64 v[16:17], v18 offset:4096
  s_waitcnt vmcnt(14)
  v_cvt_f32_i32 v96, v96
  v_cvt_f32_i32 v97, v97
  v_cvt_f32_i32 v98, v98
  v_cvt_f32_i32 v99, v99
  v_cvt_f32_i32 v100, v100
  v_cvt_f32_i32 v101, v101
  v_cvt_f32_i32 v102, v102
  v_cvt_f32_i32 v103, v103
  s_waitcnt vmcnt(12)
  v_cvt_f32_i32 v104, v104
  v_cvt_f32_i32 v105, v105
  v_cvt_f32_i32 v106, v106
  v_cvt_f32_i32 v107, v107
  v_cvt_f32_i32 v108, v108
  v_cvt_f32_i32 v109, v109
  v_cvt_f32_i32 v110, v110
  v_cvt_f32_i32 v111, v111
  v_cvt_pk_bf16_f32 v44, v96, v104
  v_cvt_pk_bf16_f32 v46, v97, v105
  v_cvt_pk_bf16_f32 v48, v98, v106
  v_cvt_pk_bf16_f32 v50, v99, v107
  v_cvt_pk_bf16_f32 v52, v100, v108
  v_cvt_pk_bf16_f32 v54, v101, v109
  v_cvt_pk_bf16_f32 v56, v102, v110
  v_cvt_pk_bf16_f32 v58, v103, v111
  s_waitcnt lgkmcnt(0)
  v_sub_f32 v20, v20, v6
  v_exp_f32 v20, v20
  v_lshlrev_b32 v21, 16, v21
  v_mul_f32 v21, v21, v20
  v_add_f32 v7, v7, v20
  s_nop 0
  v_mov_b32_dpp v20, v21 row_ror:12 row_mask:0xf bank_mask:0xf
  v_cvt_pk_bf16_f32 v14, v21, v20
  s_nop 1
  v_mov_b32_dpp v15, v14 row_ror:8 row_mask:0xf bank_mask:0xf
  s_waitcnt vmcnt(10)
  v_cvt_f32_i32 v112, v112
  v_cvt_f32_i32 v113, v113
  v_cvt_f32_i32 v114, v114
  v_cvt_f32_i32 v115, v115
  v_cvt_f32_i32 v116, v116
  v_cvt_f32_i32 v117, v117
  v_cvt_f32_i32 v118, v118
  v_cvt_f32_i32 v119, v119
  s_waitcnt vmcnt(8)
  v_cvt_f32_i32 v120, v120
  v_cvt_f32_i32 v121, v121
  v_cvt_f32_i32 v122, v122
  v_cvt_f32_i32 v123, v123
  v_cvt_f32_i32 v124, v124
  v_cvt_f32_i32 v125, v125
  v_cvt_f32_i32 v126, v126
  v_cvt_f32_i32 v127, v127
  v_cvt_pk_bf16_f32 v45, v112, v120
  v_cvt_pk_bf16_f32 v47, v113, v121
  v_cvt_pk_bf16_f32 v49, v114, v122
  v_cvt_pk_bf16_f32 v51, v115, v123
  v_cvt_pk_bf16_f32 v53, v116, v124
  v_cvt_pk_bf16_f32 v55, v117, v125
  v_cvt_pk_bf16_f32 v57, v118, v126
  v_cvt_pk_bf16_f32 v59, v119, v127
  buffer_load_dwordx4 v[96:99], v4, s[44:47], s32 offen offset:0 nt
  buffer_load_dwordx4 v[100:103], v4, s[44:47], s32 offen offset:256 nt
  buffer_load_dwordx4 v[104:107], v4, s[44:47], s32 offen offset:512 nt
  buffer_load_dwordx4 v[108:111], v4, s[44:47], s32 offen offset:768 nt
  buffer_load_dwordx4 v[112:115], v4, s[44:47], s32 offen offset:1024 nt
  buffer_load_dwordx4 v[116:119], v4, s[44:47], s32 offen offset:1280 nt
  buffer_load_dwordx4 v[120:123], v4, s[44:47], s32 offen offset:1536 nt
  buffer_load_dwordx4 v[124:127], v4, s[44:47], s32 offen offset:1792 nt
  s_add_u32 s32, s32, 32768
  v_mfma_f32_16x16x16_bf16 v[92:95], v[16:17], v[14:15], v[92:95]
  v_mfma_f32_16x16x16_bf16 v[60:63], v[44:45], v[14:15], v[60:63]
  v_mfma_f32_16x16x16_bf16 v[64:67], v[46:47], v[14:15], v[64:67]
  v_mfma_f32_16x16x16_bf16 v[68:71], v[48:49], v[14:15], v[68:71]
  v_mfma_f32_16x16x16_bf16 v[72:75], v[50:51], v[14:15], v[72:75]
  v_mfma_f32_16x16x16_bf16 v[76:79], v[52:53], v[14:15], v[76:79]
  v_mfma_f32_16x16x16_bf16 v[80:83], v[54:55], v[14:15], v[80:83]
  v_mfma_f32_16x16x16_bf16 v[84:87], v[56:57], v[14:15], v[84:87]
  v_mfma_f32_16x16x16_bf16 v[88:91], v[58:59], v[14:15], v[88:91]
  ds_read_b32 v20, v19 offset:256
  ds_read_u16 v21, v5 offset:128
  ds_read_b64 v[16:17], v18 offset:4224
  s_waitcnt vmcnt(14)
  v_cvt_f32_i32 v128, v128
  v_cvt_f32_i32 v129, v129
  v_cvt_f32_i32 v130, v130
  v_cvt_f32_i32 v131, v131
  v_cvt_f32_i32 v132, v132
  v_cvt_f32_i32 v133, v133
  v_cvt_f32_i32 v134, v134
  v_cvt_f32_i32 v135, v135
  s_waitcnt vmcnt(12)
  v_cvt_f32_i32 v136, v136
  v_cvt_f32_i32 v137, v137
  v_cvt_f32_i32 v138, v138
  v_cvt_f32_i32 v139, v139
  v_cvt_f32_i32 v140, v140
  v_cvt_f32_i32 v141, v141
  v_cvt_f32_i32 v142, v142
  v_cvt_f32_i32 v143, v143
  v_cvt_pk_bf16_f32 v44, v128, v136
  v_cvt_pk_bf16_f32 v46, v129, v137
  v_cvt_pk_bf16_f32 v48, v130, v138
  v_cvt_pk_bf16_f32 v50, v131, v139
  v_cvt_pk_bf16_f32 v52, v132, v140
  v_cvt_pk_bf16_f32 v54, v133, v141
  v_cvt_pk_bf16_f32 v56, v134, v142
  v_cvt_pk_bf16_f32 v58, v135, v143
  s_waitcnt lgkmcnt(0)
  v_sub_f32 v20, v20, v6
  v_exp_f32 v20, v20
  v_lshlrev_b32 v21, 16, v21
  v_mul_f32 v21, v21, v20
  v_add_f32 v7, v7, v20
  s_nop 0
  v_mov_b32_dpp v20, v21 row_ror:12 row_mask:0xf bank_mask:0xf
  v_cvt_pk_bf16_f32 v14, v21, v20
  s_nop 1
  v_mov_b32_dpp v15, v14 row_ror:8 row_mask:0xf bank_mask:0xf
  s_waitcnt vmcnt(10)
  v_cvt_f32_i32 v144, v144
  v_cvt_f32_i32 v145, v145
  v_cvt_f32_i32 v146, v146
  v_cvt_f32_i32 v147, v147
  v_cvt_f32_i32 v148, v148
  v_cvt_f32_i32 v149, v149
  v_cvt_f32_i32 v150, v150
  v_cvt_f32_i32 v151, v151
  s_waitcnt vmcnt(8)
  v_cvt_f32_i32 v152, v152
  v_cvt_f32_i32 v153, v153
  v_cvt_f32_i32 v154, v154
  v_cvt_f32_i32 v155, v155
  v_cvt_f32_i32 v156, v156
  v_cvt_f32_i32 v157, v157
  v_cvt_f32_i32 v158, v158
  v_cvt_f32_i32 v159, v159
  v_cvt_pk_bf16_f32 v45, v144, v152
  v_cvt_pk_bf16_f32 v47, v145, v153
  v_cvt_pk_bf16_f32 v49, v146, v154
  v_cvt_pk_bf16_f32 v51, v147, v155
  v_cvt_pk_bf16_f32 v53, v148, v156
  v_cvt_pk_bf16_f32 v55, v149, v157
  v_cvt_pk_bf16_f32 v57, v150, v158
  v_cvt_pk_bf16_f32 v59, v151, v159
  buffer_load_dwordx4 v[128:131], v4, s[44:47], s32 offen offset:0 nt
  buffer_load_dwordx4 v[132:135], v4, s[44:47], s32 offen offset:256 nt
  buffer_load_dwordx4 v[136:139], v4, s[44:47], s32 offen offset:512 nt
  buffer_load_dwordx4 v[140:143], v4, s[44:47], s32 offen offset:768 nt
  buffer_load_dwordx4 v[144:147], v4, s[44:47], s32 offen offset:1024 nt
  buffer_load_dwordx4 v[148:151], v4, s[44:47], s32 offen offset:1280 nt
  buffer_load_dwordx4 v[152:155], v4, s[44:47], s32 offen offset:1536 nt
  buffer_load_dwordx4 v[156:159], v4, s[44:47], s32 offen offset:1792 nt
  s_add_u32 s32, s32, 32768
  v_mfma_f32_16x16x16_bf16 v[92:95], v[16:17], v[14:15], v[92:95]
  v_mfma_f32_16x16x16_bf16 v[60:63], v[44:45], v[14:15], v[60:63]
  v_mfma_f32_16x16x16_bf16 v[64:67], v[46:47], v[14:15], v[64:67]
  v_mfma_f32_16x16x16_bf16 v[68:71], v[48:49], v[14:15], v[68:71]
  v_mfma_f32_16x16x16_bf16 v[72:75], v[50:51], v[14:15], v[72:75]
  v_mfma_f32_16x16x16_bf16 v[76:79], v[52:53], v[14:15], v[76:79]
  v_mfma_f32_16x16x16_bf16 v[80:83], v[54:55], v[14:15], v[80:83]
  v_mfma_f32_16x16x16_bf16 v[84:87], v[56:57], v[14:15], v[84:87]
  v_mfma_f32_16x16x16_bf16 v[88:91], v[58:59], v[14:15], v[88:91]
  v_add_u32 v19, 512, v19
  v_add_u32 v5, 256, v5
  v_add_u32 v18, 256, v18
  ds_read_b32 v20, v19 offset:0
  ds_read_u16 v21, v5 offset:0
  ds_read_b64 v[36:37], v18 offset:4096
  ds_read_b32 v22, v19 offset:256
  ds_read_u16 v23, v5 offset:128
  ds_read_b64 v[38:39], v18 offset:4224
  s_waitcnt lgkmcnt(0)
  v_sub_f32 v20, v20, v6
  v_exp_f32 v20, v20
  v_lshlrev_b32 v21, 16, v21
  v_mul_f32 v21, v21, v20
  v_add_f32 v7, v7, v20
  s_nop 0
  v_mov_b32_dpp v20, v21 row_ror:12 row_mask:0xf bank_mask:0xf
  v_cvt_pk_bf16_f32 v10, v21, v20
  s_nop 1
  v_mov_b32_dpp v11, v10 row_ror:8 row_mask:0xf bank_mask:0xf
  v_sub_f32 v22, v22, v6
  v_exp_f32 v22, v22
  v_lshlrev_b32 v23, 16, v23
  v_mul_f32 v23, v23, v22
  v_add_f32 v7, v7, v22
  s_nop 0
  v_mov_b32_dpp v22, v23 row_ror:12 row_mask:0xf bank_mask:0xf
  v_cvt_pk_bf16_f32 v12, v23, v22
  s_nop 1
  v_mov_b32_dpp v13, v12 row_ror:8 row_mask:0xf bank_mask:0xf
  s_nop 1
  v_add_f32_dpp v7, v7, v7 row_ror:4 row_mask:0xf bank_mask:0xf
  s_nop 1
  v_add_f32_dpp v7, v7, v7 row_ror:8 row_mask:0xf bank_mask:0xf
  v_mov_b32 v27, v7
  s_nop 1
  v_permlane16_swap_b32 v7, v27
  v_add_f32 v7, v7, v27
  v_mov_b32 v27, v7
  s_nop 1
  v_permlane32_swap_b32 v7, v27
  v_add_f32 v7, v7, v27
  v_and_b32 v20, 15, v0
  v_lshrrev_b32 v21, 4, v0
  s_lshl_b32 s37, s3, 5
  s_add_u32 s37, s37, 33792
  v_lshl_add_u32 v23, v20, 3, s37
  s_lshl_b32 s37, s3, 11
  s_add_u32 s37, s37, 25600
  v_lshlrev_b32 v22, 9, v20
  v_lshl_add_u32 v22, v21, 6, v22
  v_add_u32 v22, s37, v22
  v_cmp_gt_u32 s[62:63], 4, v20
  v_lshlrev_b32 v26, 4, v0
  v_lshlrev_b32 v27, 3, v0
  s_mov_b64 exec, s[62:63]
  ds_write_b64 v23, v[6:7]
  s_mov_b64 exec, -1
  v_lshlrev_b32 v24, 5, v0
  v_lshlrev_b32 v25, 3, v21
  s_cmp_lg_u32 s3, 0
  s_cbranch_scc1 L_noticket
  s_atomic_add s90, s[20:21], s91 glc
L_noticket:
  s_waitcnt vmcnt(14)
  v_cvt_f32_i32 v96, v96
  v_cvt_f32_i32 v97, v97
  v_cvt_f32_i32 v98, v98
  v_cvt_f32_i32 v99, v99
  v_cvt_f32_i32 v100, v100
  v_cvt_f32_i32 v101, v101
  v_cvt_f32_i32 v102, v102
  v_cvt_f32_i32 v103, v103
  s_waitcnt vmcnt(12)
  v_cvt_f32_i32 v104, v104
  v_cvt_f32_i32 v105, v105
  v_cvt_f32_i32 v106, v106
  v_cvt_f32_i32 v107, v107
  v_cvt_f32_i32 v108, v108
  v_cvt_f32_i32 v109, v109
  v_cvt_f32_i32 v110, v110
  v_cvt_f32_i32 v111, v111
  v_cvt_pk_bf16_f32 v44, v96, v104
  v_cvt_pk_bf16_f32 v46, v97, v105
  v_cvt_pk_bf16_f32 v48, v98, v106
  v_cvt_pk_bf16_f32 v50, v99, v107
  v_cvt_pk_bf16_f32 v52, v100, v108
  v_cvt_pk_bf16_f32 v54, v101, v109
  v_cvt_pk_bf16_f32 v56, v102, v110
  v_cvt_pk_bf16_f32 v58, v103, v111
  s_waitcnt vmcnt(10)
  v_cvt_f32_i32 v112, v112
  v_cvt_f32_i32 v113, v113
  v_cvt_f32_i32 v114, v114
  v_cvt_f32_i32 v115, v115
  v_cvt_f32_i32 v116, v116
  v_cvt_f32_i32 v117, v117
  v_cvt_f32_i32 v118, v118
  v_cvt_f32_i32 v119, v119
  s_waitcnt vmcnt(8)
  v_cvt_f32_i32 v120, v120
  v_cvt_f32_i32 v121, v121
  v_cvt_f32_i32 v122, v122
  v_cvt_f32_i32 v123, v123
  v_cvt_f32_i32 v124, v124
  v_cvt_f32_i32 v125, v125
  v_cvt_f32_i32 v126, v126
  v_cvt_f32_i32 v127, v127
  v_cvt_pk_bf16_f32 v45, v112, v120
  v_cvt_pk_bf16_f32 v47, v113, v121
  v_cvt_pk_bf16_f32 v49, v114, v122
  v_cvt_pk_bf16_f32 v51, v115, v123
  v_cvt_pk_bf16_f32 v53, v116, v124
  v_cvt_pk_bf16_f32 v55, v117, v125
  v_cvt_pk_bf16_f32 v57, v118, v126
  v_cvt_pk_bf16_f32 v59, v119, v127
  s_nop 1
  v_mfma_f32_16x16x16_bf16 v[92:95], v[36:37], v[10:11], v[92:95]
  v_mfma_f32_16x16x16_bf16 v[60:63], v[44:45], v[10:11], v[60:63]
  v_mfma_f32_16x16x16_bf16 v[64:67], v[46:47], v[10:11], v[64:67]
  v_mfma_f32_16x16x16_bf16 v[68:71], v[48:49], v[10:11], v[68:71]
  v_mfma_f32_16x16x16_bf16 v[72:75], v[50:51], v[10:11], v[72:75]
  v_mfma_f32_16x16x16_bf16 v[76:79], v[52:53], v[10:11], v[76:79]
  v_mfma_f32_16x16x16_bf16 v[80:83], v[54:55], v[10:11], v[80:83]
  v_mfma_f32_16x16x16_bf16 v[84:87], v[56:57], v[10:11], v[84:87]
  v_mfma_f32_16x16x16_bf16 v[88:91], v[58:59], v[10:11], v[88:91]
  s_waitcnt vmcnt(6)
  v_cvt_f32_i32 v128, v128
  v_cvt_f32_i32 v129, v129
  v_cvt_f32_i32 v130, v130
  v_cvt_f32_i32 v131, v131
  v_cvt_f32_i32 v132, v132
  v_cvt_f32_i32 v133, v133
  v_cvt_f32_i32 v134, v134
  v_cvt_f32_i32 v135, v135
  s_waitcnt vmcnt(4)
  v_cvt_f32_i32 v136, v136
  v_cvt_f32_i32 v137, v137
  v_cvt_f32_i32 v138, v138
  v_cvt_f32_i32 v139, v139
  v_cvt_f32_i32 v140, v140
  v_cvt_f32_i32 v141, v141
  v_cvt_f32_i32 v142, v142
  v_cvt_f32_i32 v143, v143
  v_cvt_pk_bf16_f32 v44, v128, v136
  v_cvt_pk_bf16_f32 v46, v129, v137
  v_cvt_pk_bf16_f32 v48, v130, v138
  v_cvt_pk_bf16_f32 v50, v131, v139
  v_cvt_pk_bf16_f32 v52, v132, v140
  v_cvt_pk_bf16_f32 v54, v133, v141
  v_cvt_pk_bf16_f32 v56, v134, v142
  v_cvt_pk_bf16_f32 v58, v135, v143
  s_waitcnt vmcnt(2)
  v_cvt_f32_i32 v144, v144
  v_cvt_f32_i32 v145, v145
  v_cvt_f32_i32 v146, v146
  v_cvt_f32_i32 v147, v147
  v_cvt_f32_i32 v148, v148
  v_cvt_f32_i32 v149, v149
  v_cvt_f32_i32 v150, v150
  v_cvt_f32_i32 v151, v151
  s_waitcnt vmcnt(0)
  v_cvt_f32_i32 v152, v152
  v_cvt_f32_i32 v153, v153
  v_cvt_f32_i32 v154, v154
  v_cvt_f32_i32 v155, v155
  v_cvt_f32_i32 v156, v156
  v_cvt_f32_i32 v157, v157
  v_cvt_f32_i32 v158, v158
  v_cvt_f32_i32 v159, v159
  v_cvt_pk_bf16_f32 v45, v144, v152
  v_cvt_pk_bf16_f32 v47, v145, v153
  v_cvt_pk_bf16_f32 v49, v146, v154
  v_cvt_pk_bf16_f32 v51, v147, v155
  v_cvt_pk_bf16_f32 v53, v148, v156
  v_cvt_pk_bf16_f32 v55, v149, v157
  v_cvt_pk_bf16_f32 v57, v150, v158
  v_cvt_pk_bf16_f32 v59, v151, v159
  s_nop 1
  s_cmp_lg_u32 s3, 0
  s_cbranch_scc1 L_nopf
  s_waitcnt lgkmcnt(0)
  s_lshr_b32 s90, s90, s89
  s_and_b32 s90, s90, 0xffff
  s_cbranch_scc0 L_nopf
  buffer_load_dwordx4 v[28:31], v26, s[52:55], s88 offen sc0 sc1
  buffer_load_dwordx4 v[32:35], v26, s[52:55], s88 offen offset:1024 sc0 sc1
  buffer_load_dwordx2 v[36:37], v27, s[52:55], s88 offen offset:2048 sc0 sc1
L_nopf:
  v_mfma_f32_16x16x16_bf16 v[92:95], v[38:39], v[12:13], v[92:95]
  v_mfma_f32_16x16x16_bf16 v[60:63], v[44:45], v[12:13], v[60:63]
  v_mfma_f32_16x16x16_bf16 v[64:67], v[46:47], v[12:13], v[64:67]
  v_mfma_f32_16x16x16_bf16 v[68:71], v[48:49], v[12:13], v[68:71]
  v_mfma_f32_16x16x16_bf16 v[72:75], v[50:51], v[12:13], v[72:75]
  v_mfma_f32_16x16x16_bf16 v[76:79], v[52:53], v[12:13], v[76:79]
  v_mfma_f32_16x16x16_bf16 v[80:83], v[54:55], v[12:13], v[80:83]
  v_mfma_f32_16x16x16_bf16 v[84:87], v[56:57], v[12:13], v[84:87]
  v_mfma_f32_16x16x16_bf16 v[88:91], v[58:59], v[12:13], v[88:91]
  s_nop 7
  s_mov_b64 exec, s[62:63]
  v_sub_f32 v96, v60, v92
  v_sub_f32 v97, v64, v92
  v_sub_f32 v98, v68, v92
  v_sub_f32 v99, v72, v92
  ds_write_b128 v22, v[96:99] offset:0
  v_sub_f32 v100, v61, v92
  v_sub_f32 v101, v65, v92
  v_sub_f32 v102, v69, v92
  v_sub_f32 v103, v73, v92
  ds_write_b128 v22, v[100:103] offset:16
  v_sub_f32 v104, v62, v92
  v_sub_f32 v105, v66, v92
  v_sub_f32 v106, v70, v92
  v_sub_f32 v107, v74, v92
  ds_write_b128 v22, v[104:107] offset:32
  v_sub_f32 v108, v63, v92
  v_sub_f32 v109, v67, v92
  v_sub_f32 v110, v71, v92
  v_sub_f32 v111, v75, v92
  ds_write_b128 v22, v[108:111] offset:48
  v_sub_f32 v112, v76, v92
  v_sub_f32 v113, v80, v92
  v_sub_f32 v114, v84, v92
  v_sub_f32 v115, v88, v92
  ds_write_b128 v22, v[112:115] offset:256
  v_sub_f32 v116, v77, v92
  v_sub_f32 v117, v81, v92
  v_sub_f32 v118, v85, v92
  v_sub_f32 v119, v89, v92
  ds_write_b128 v22, v[116:119] offset:272
  v_sub_f32 v120, v78, v92
  v_sub_f32 v121, v82, v92
  v_sub_f32 v122, v86, v92
  v_sub_f32 v123, v90, v92
  ds_write_b128 v22, v[120:123] offset:288
  v_sub_f32 v124, v79, v92
  v_sub_f32 v125, v83, v92
  v_sub_f32 v126, v87, v92
  v_sub_f32 v127, v91, v92
  ds_write_b128 v22, v[124:127] offset:304
  s_mov_b64 exec, -1
  s_waitcnt lgkmcnt(0)
  s_barrier
  s_cmp_lg_u32 s3, 0
  s_cbranch_scc1 L_end
  ds_read_b64 v[44:45], v25 offset:33792
  ds_read_b64 v[46:47], v25 offset:33824
  ds_read_b64 v[48:49], v25 offset:33856
  ds_read_b64 v[50:51], v25 offset:33888
  ds_read_b128 v[96:99], v24 offset:25600
  ds_read_b128 v[100:103], v24 offset:25616
  ds_read_b128 v[104:107], v24 offset:27648
  ds_read_b128 v[108:111], v24 offset:27664
  ds_read_b128 v[112:115], v24 offset:29696
  ds_read_b128 v[116:119], v24 offset:29712
  ds_read_b128 v[120:123], v24 offset:31744
  ds_read_b128 v[124:127], v24 offset:31760
  s_waitcnt lgkmcnt(8)
  v_max3_f32 v6, v44, v46, v48
  v_max_f32 v6, v6, v50
  v_sub_f32 v44, v44, v6
  v_sub_f32 v46, v46, v6
  v_sub_f32 v48, v48, v6
  v_sub_f32 v50, v50, v6
  v_exp_f32 v44, v44
  v_exp_f32 v46, v46
  v_exp_f32 v48, v48
  v_exp_f32 v50, v50
  s_nop 0
  v_mul_f32 v7, v44, v45
  v_fmac_f32 v7, v46, v47
  v_fmac_f32 v7, v48, v49
  v_fmac_f32 v7, v50, v51
  s_waitcnt lgkmcnt(0)
  v_pk_mul_f32 v[60:61], v[96:97], v[44:45] op_sel_hi:[1,0]
  v_pk_mul_f32 v[62:63], v[98:99], v[44:45] op_sel_hi:[1,0]
  v_pk_mul_f32 v[64:65], v[100:101], v[44:45] op_sel_hi:[1,0]
  v_pk_mul_f32 v[66:67], v[102:103], v[44:45] op_sel_hi:[1,0]
  v_pk_fma_f32 v[60:61], v[104:105], v[46:47], v[60:61] op_sel_hi:[1,0,1]
  v_pk_fma_f32 v[62:63], v[106:107], v[46:47], v[62:63] op_sel_hi:[1,0,1]
  v_pk_fma_f32 v[64:65], v[108:109], v[46:47], v[64:65] op_sel_hi:[1,0,1]
  v_pk_fma_f32 v[66:67], v[110:111], v[46:47], v[66:67] op_sel_hi:[1,0,1]
  v_pk_fma_f32 v[60:61], v[112:113], v[48:49], v[60:61] op_sel_hi:[1,0,1]
  v_pk_fma_f32 v[62:63], v[114:115], v[48:49], v[62:63] op_sel_hi:[1,0,1]
  v_pk_fma_f32 v[64:65], v[116:117], v[48:49], v[64:65] op_sel_hi:[1,0,1]
  v_pk_fma_f32 v[66:67], v[118:119], v[48:49], v[66:67] op_sel_hi:[1,0,1]
  v_pk_fma_f32 v[60:61], v[120:121], v[50:51], v[60:61] op_sel_hi:[1,0,1]
  v_pk_fma_f32 v[62:63], v[122:123], v[50:51], v[62:63] op_sel_hi:[1,0,1]
  v_pk_fma_f32 v[64:65], v[124:125], v[50:51], v[64:65] op_sel_hi:[1,0,1]
  v_pk_fma_f32 v[66:67], v[126:127], v[50:51], v[66:67] op_sel_hi:[1,0,1]
  s_cmp_lg_u32 s90, 0
  s_cbranch_scc1 L_second
  buffer_store_dwordx4 v[60:63], v26, s[52:55], s87 offen sc0 sc1
  buffer_store_dwordx4 v[64:67], v26, s[52:55], s87 offen offset:1024 sc0 sc1
  buffer_store_dwordx2 v[6:7], v27, s[52:55], s87 offen offset:2048 sc0 sc1
  s_branch L_fin
L_repoll:
  buffer_load_dwordx4 v[28:31], v26, s[52:55], s88 offen sc0 sc1
  buffer_load_dwordx4 v[32:35], v26, s[52:55], s88 offen offset:1024 sc0 sc1
  buffer_load_dwordx2 v[36:37], v27, s[52:55], s88 offen offset:2048 sc0 sc1
L_second:
  s_waitcnt vmcnt(0)
  v_max3_u32 v20, v28, v29, v30
  v_max3_u32 v20, v20, v31, v32
  v_max3_u32 v20, v20, v33, v34
  v_max3_u32 v20, v20, v35, v36
  v_max_u32 v20, v20, v37
  v_cmp_eq_u32 vcc, -1, v20
  s_cbranch_vccnz L_repoll
  v_max_f32 v20, v6, v36
  v_sub_f32 v21, v6, v20
  v_sub_f32 v22, v36, v20
  v_exp_f32 v21, v21
  v_exp_f32 v22, v22
  s_nop 0
  v_mul_f32 v23, v21, v7
  v_fmac_f32 v23, v22, v37
  v_rcp_f32 v23, v23
  s_nop 0
  v_mul_f32 v20, v21, v23
  v_mul_f32 v22, v22, v23
  v_pk_mul_f32 v[60:61], v[60:61], v[20:21] op_sel_hi:[1,0]
  v_pk_mul_f32 v[62:63], v[62:63], v[20:21] op_sel_hi:[1,0]
  v_pk_mul_f32 v[64:65], v[64:65], v[20:21] op_sel_hi:[1,0]
  v_pk_mul_f32 v[66:67], v[66:67], v[20:21] op_sel_hi:[1,0]
  v_pk_fma_f32 v[60:61], v[28:29], v[22:23], v[60:61] op_sel_hi:[1,0,1]
  v_pk_fma_f32 v[62:63], v[30:31], v[22:23], v[62:63] op_sel_hi:[1,0,1]
  v_pk_fma_f32 v[64:65], v[32:33], v[22:23], v[64:65] op_sel_hi:[1,0,1]
  v_pk_fma_f32 v[66:67], v[34:35], v[22:23], v[66:67] op_sel_hi:[1,0,1]
  v_cvt_pk_bf16_f32 v68, v60, v61
  v_cvt_pk_bf16_f32 v69, v62, v63
  v_cvt_pk_bf16_f32 v70, v64, v65
  v_cvt_pk_bf16_f32 v71, v66, v67
  buffer_store_dwordx4 v[68:71], v26, s[56:59], s39 offen
L_fin:
L_end:
  s_endpgm
.section .rodata,"a"
.p2align 6
.amdhsa_kernel standalone__kv_cache_quant_int4_int2_kv_with_per_channel_or_per_token_scales__sampling_kernel
  .amdhsa_next_free_vgpr 160
  .amdhsa_next_free_sgpr 96
  .amdhsa_accum_offset 160
  .amdhsa_group_segment_fixed_size 0
  .amdhsa_kernarg_size 80
  .amdhsa_user_sgpr_count 2
  .amdhsa_user_sgpr_kernarg_segment_ptr 1
  .amdhsa_system_sgpr_workgroup_id_x 1
.end_amdhsa_kernel
```
